```python
import torch

def _softmax(x, axis=-1):
    return torch.softmax(x, dim=axis)
def _gelu(x):
    return torch.nn.functional.gelu(x, approximate="tanh")
def _silu(x):
    return torch.nn.functional.silu(x)
def _sigmoid(x):
    return torch.sigmoid(x)
def _layernorm(x, axis=-1, eps=1e-5):
    m = x.mean(dim=axis, keepdim=True)
    v = x.var(dim=axis, keepdim=True, unbiased=False)
    return (x - m) / torch.sqrt(v + eps)
def _scatter_add(tgt, idx, src, axis=0):
    return tgt.clone().index_add_(axis, idx, src)
def _segment_sum(src, seg, n):
    out = torch.zeros((n,) + src.shape[1:], dtype=src.dtype)
    return out.index_add_(0, seg, src)
def _pad(x, pw):
    flat = tuple(v for pair in reversed(pw) for v in pair)
    return torch.nn.functional.pad(x, flat)

kernel_name = 'gated_mix__softmax_full_mha__moe_arch_mod__prompt'

def setup_inputs():

    _w = (lambda a: (lambda t: t.to(torch.bfloat16) if t.is_floating_point() else t)(torch.as_tensor(a)))
    def _A_setup():
        B, S, D = 1, 2048, 1024
        return {
            "x": _w((lambda *s: torch.randn(*s, dtype=torch.bfloat16) * 0.05)(B, S, D)),
            "wqkv": _w((lambda *s: torch.randn(*s, dtype=torch.bfloat16) * 0.8)(D, 3 * D)),
            "wo": _w((lambda *s: torch.randn(*s, dtype=torch.bfloat16) * 0.1)(D, D)),
        }
    _A_in = _A_setup()

    def _B_setup():
        B, S, D, F, C = 1, 2048, 1024, 3584, 1
        return {
            "x": _w((lambda *s: torch.randn(*s, dtype=torch.bfloat16) * 0.05)(B, S, D)),
            "w_r": _w((lambda *s: torch.randn(*s, dtype=torch.bfloat16) * 3.2)(D)),
            "w_gate": _w((lambda *s: torch.randn(*s, dtype=torch.bfloat16) * 0.2)(D, F)),
            "w_up": _w((lambda *s: torch.randn(*s, dtype=torch.bfloat16) * 0.2)(D, F)),
            "w_down": _w((lambda *s: torch.randn(*s, dtype=torch.bfloat16) * 0.2)(F, D)),
        }
    _B_in = _B_setup()

    return {
        "A_x": _A_in["x"],
        "A_wqkv": _A_in["wqkv"],
        "A_wo": _A_in["wo"],
        "B_x": _B_in["x"],
        "B_w_r": _B_in["w_r"],
        "B_w_gate": _B_in["w_gate"],
        "B_w_up": _B_in["w_up"],
        "B_w_down": _B_in["w_down"],
        "gate_w": _w((lambda *s: torch.randn(*s, dtype=torch.bfloat16) * 0.05)(1024) * 16.0),
    }

def reference(A_x, A_wqkv, A_wo, B_x, B_w_r, B_w_gate, B_w_up, B_w_down, gate_w):
    def _A_ref(x, wqkv, wo):
        B, S, D = x.shape
        H = 32; Dh = D // H
        qkv = (lambda x, *d: x.permute(*d))((x @ wqkv).reshape(B, S, 3, H, Dh), 2, 0, 3, 1, 4)
        q, k, v = qkv[0], qkv[1], qkv[2]
        scale = Dh ** -0.5
        scores = torch.einsum("bhqd,bhkd->bhqk", q, k) * scale
        p = _softmax(scores, axis=-1)
        o = torch.einsum("bhqk,bhkd->bhqd", p, v)
        return (lambda x, *d: x.permute(*d))(o, 0, 2, 1, 3).reshape(B, S, D) @ wo

    def _B_ref(x, w_r, w_gate, w_up, w_down):
        B, S, D = x.shape
        C = 1
        r = x @ w_r
        idx = torch.argsort(-r, axis=-1)[:, :C]
        idx_e = (lambda x, n, axis: torch.repeat_interleave(x, n, dim=axis))(idx.reshape(B, C, 1), D, axis=2)
        x_sel = (lambda x, i, axis: torch.take_along_dim(x, i, dim=axis))(x, idx_e, axis=1)
        g = _silu(x_sel @ w_gate)
        u = x_sel @ w_up
        y = (g * u) @ w_down
        r_sel = _sigmoid((lambda x, i, axis: torch.take_along_dim(x, i, dim=axis))(r, idx, axis=1))
        y = y * r_sel.reshape(B, C, 1)
        b_off = (torch.arange(B) * S).reshape(B, 1)
        flat_idx = (idx + b_off).reshape(B * C)
        zero = (x * 0.0).reshape(B * S, D)
        upd = _scatter_add(zero, flat_idx, y.reshape(B * C, D), axis=0)
        return x + upd.reshape(B, S, D)

    x = A_x
    g = _sigmoid((x * gate_w).sum(-1, keepdims=True))
    a = _A_ref(x, A_wqkv, A_wo)
    b = _B_ref(x, B_w_r, B_w_gate, B_w_up, B_w_down)
    return g * a + (1 - g) * b
```

```asm
; @launch grid=(256,1,1) block=(512,1,1) lds=163840
.amdgcn_target "amdgcn-amd-amdhsa--gfx950"
.text
.globl gated_mix__softmax_full_mha__moe_arch_mod__prompt_kernel
.p2align 8
.type gated_mix__softmax_full_mha__moe_arch_mod__prompt_kernel,@function
gated_mix__softmax_full_mha__moe_arch_mod__prompt_kernel:

    s_cmp_ge_u32 s2, 256
    s_cbranch_scc1 L_exit
    s_load_dwordx2 s[8:9], s[0:1], 0
    s_load_dwordx2 s[12:13], s[0:1], 8
    s_load_dwordx2 s[16:17], s[0:1], 88
    s_load_dwordx2 s[56:57], s[0:1], 32
    s_load_dwordx2 s[60:61], s[0:1], 64
    s_load_dwordx2 s[36:37], s[0:1], 16
    s_load_dwordx2 s[40:41], s[0:1], 72
    s_load_dwordx2 s[44:45], s[0:1], 40
    s_load_dwordx2 s[48:49], s[0:1], 48
    s_load_dwordx2 s[52:53], s[0:1], 56
    v_lshrrev_b32 v1, 6, v0
    v_and_b32 v0, 63, v0
    v_readfirstlane_b32 s22, v1
    s_and_b32 s3, s2, 7
    s_lshr_b32 s4, s2, 3
    s_and_b32 s21, s4, 15
    s_lshr_b32 s5, s4, 4
    s_lshl_b32 s6, s3, 2
    s_lshr_b32 s6, 0x76243510, s6
    s_and_b32 s94, s6, 7
    s_lshl_b32 s20, s94, 1
    s_add_u32 s20, s20, s5
    s_mov_b32 s10, 0x400000
    s_mov_b32 s11, 0x20000
    s_mov_b32 s14, 0x600000
    s_mov_b32 s15, 0x20000
    s_mov_b32 s18, 0x10000000
    s_mov_b32 s19, 0x20000
    s_cmp_lt_u32 s22, 4
    s_cbranch_scc1 L_cons
    s_mul_i32 s65, s3, 1
    v_lshrrev_b32 v2, 3, v0
    v_lshrrev_b32 v3, 4, v0
    v_and_b32 v4, 7, v0
    s_cmp_eq_u32 s22, 7
    s_cbranch_scc1 L_help
    s_sub_u32 s7, s22, 4
    s_mul_i32 s6, s7, 3
    s_min_u32 s6, s6, 5
    v_xor_b32 v5, v4, v3
    s_and_b32 s5, s6, 1
    s_lshl_b32 s5, s5, 2
    v_xor_b32 v5, s5, v5
    v_xor_b32 v6, 4, v5
    s_lshl_b32 s5, s21, 4
    s_add_u32 s5, s5, s6
    s_lshl_b32 s5, s5, 3
    v_add_u32 v7, s5, v2
    v_lshlrev_b32 v7, 11, v7
    v_lshl_add_u32 v88, v5, 4, v7
    v_lshl_add_u32 v6, v6, 4, v7
    v_add_u32 v89, 15360, v6
    v_add_u32 v90, 30720, v88
    v_and_b32 v3, 1, v3
    v_lshlrev_b32 v3, 2, v3
    v_xor_b32 v4, v4, v3
    v_mul_u32_u24 v2, 6144, v2
    v_lshl_add_u32 v2, v4, 4, v2
    s_lshl_b32 s5, s20, 7
    s_lshl_b32 s88, s7, 11
    s_add_u32 s5, s5, s88
    v_add_u32 v92, s5, v2
    v_xor_b32 v5, 32, v92
    v_add_u32 v93, 48128, v5
    v_add_u32 v94, 96256, v92
    v_add_u32 v95, 144384, v5
    s_lshl_b32 s88, s6, 10
    s_lshl_b32 s87, s7, 13
    s_add_u32 s87, s87, 16384
    s_and_b32 s78, s65, 15
    s_mov_b32 s79, 0
    s_mov_b32 s96, s78
    s_mov_b32 s97, 0
    s_mov_b32 s80, 1
    s_and_b32 s5, s20, 1
    s_lshl_b32 s98, s5, 13
    s_xor_b32 s99, s98, 8192
    s_add_u32 s98, s98, s88
    s_add_u32 s99, s99, s88
    s_lshl_b32 s90, s5, 17
    s_xor_b32 s91, s90, 131072
    s_lshl_b32 s89, s21, 18
    s_add_u32 s89, s89, s90
    s_waitcnt lgkmcnt(0)
    s_add_u32 m0, s79, s98
    s_lshl_b32 s32, s78, 7
    s_add_u32 s32, s32, s90
    buffer_load_dwordx4 v88, s[8:11], s32 offen offset:0 lds
    buffer_load_dwordx4 v89, s[8:11], s32 offen offset:1024 lds
    buffer_load_dwordx4 v90, s[8:11], s32 offen offset:2048 lds
    s_add_u32 m0, s79, s87
    s_mul_i32 s33, s78, 393216
    buffer_load_dwordx4 v92, s[12:15], s33 offen offset:0  lds
    buffer_load_dwordx4 v93, s[12:15], s33 offen offset:1024  lds
    buffer_load_dwordx4 v94, s[12:15], s33 offen offset:2048  lds
    buffer_load_dwordx4 v95, s[12:15], s33 offen offset:3072  lds
    s_add_u32 m0, m0, 4096
    s_add_u32 s33, s33, 196608
    buffer_load_dwordx4 v92, s[12:15], s33 offen offset:0  lds
    buffer_load_dwordx4 v93, s[12:15], s33 offen offset:1024  lds
    buffer_load_dwordx4 v94, s[12:15], s33 offen offset:2048  lds
    buffer_load_dwordx4 v95, s[12:15], s33 offen offset:3072  lds
    s_add_u32 m0, s97, s99
    s_lshl_b32 s32, s96, 7
    s_add_u32 s32, s32, s91
    buffer_load_dwordx4 v88, s[8:11], s32 offen offset:0 lds
    buffer_load_dwordx4 v89, s[8:11], s32 offen offset:1024 lds
    buffer_load_dwordx4 v90, s[8:11], s32 offen offset:2048 lds
    s_mov_b32 s96, s78
    s_mov_b32 s97, s79
    s_add_u32 s78, s78, 1
    s_and_b32 s78, s78, 15
    s_add_u32 s79, s79, 40960
    s_cmp_eq_u32 s79, 163840
    s_cselect_b32 s79, 0, s79
    s_add_u32 m0, s79, s98
    s_lshl_b32 s32, s78, 7
    s_add_u32 s32, s32, s90
    buffer_load_dwordx4 v88, s[8:11], s32 offen offset:0 lds
    buffer_load_dwordx4 v89, s[8:11], s32 offen offset:1024 lds
    buffer_load_dwordx4 v90, s[8:11], s32 offen offset:2048 lds
    s_add_u32 m0, s79, s87
    s_mul_i32 s33, s78, 393216
    buffer_load_dwordx4 v92, s[12:15], s33 offen offset:0  lds
    buffer_load_dwordx4 v93, s[12:15], s33 offen offset:1024  lds
    buffer_load_dwordx4 v94, s[12:15], s33 offen offset:2048  lds
    buffer_load_dwordx4 v95, s[12:15], s33 offen offset:3072  lds
    s_add_u32 m0, m0, 4096
    s_add_u32 s33, s33, 196608
    buffer_load_dwordx4 v92, s[12:15], s33 offen offset:0  lds
    buffer_load_dwordx4 v93, s[12:15], s33 offen offset:1024  lds
    buffer_load_dwordx4 v94, s[12:15], s33 offen offset:2048  lds
    buffer_load_dwordx4 v95, s[12:15], s33 offen offset:3072  lds
    s_mov_b32 s96, s78
    s_mov_b32 s97, s79
    s_add_u32 s78, s78, 1
    s_and_b32 s78, s78, 15
    s_add_u32 s79, s79, 40960
    s_cmp_eq_u32 s79, 163840
    s_cselect_b32 s79, 0, s79
    s_mov_b32 s80, 2
    s_waitcnt vmcnt(11)
    s_barrier
    s_branch L_li0
L_lp0:
    s_cmp_eq_u32 s80, 3
    s_cbranch_scc1 L_li0
    s_waitcnt vmcnt(25)
    s_barrier
L_li0:
    s_add_u32 m0, s97, s99
    s_lshl_b32 s32, s96, 7
    s_add_u32 s32, s32, s91
    buffer_load_dwordx4 v88, s[8:11], s32 offen offset:0 lds
    buffer_load_dwordx4 v89, s[8:11], s32 offen offset:1024 lds
    buffer_load_dwordx4 v90, s[8:11], s32 offen offset:2048 lds
    s_add_u32 m0, s79, s98
    s_lshl_b32 s32, s78, 7
    s_add_u32 s32, s32, s90
    buffer_load_dwordx4 v88, s[8:11], s32 offen offset:0 lds
    buffer_load_dwordx4 v89, s[8:11], s32 offen offset:1024 lds
    buffer_load_dwordx4 v90, s[8:11], s32 offen offset:2048 lds
    s_add_u32 m0, s79, s87
    s_mul_i32 s33, s78, 393216
    buffer_load_dwordx4 v92, s[12:15], s33 offen offset:0  lds
    buffer_load_dwordx4 v93, s[12:15], s33 offen offset:1024  lds
    buffer_load_dwordx4 v94, s[12:15], s33 offen offset:2048  lds
    buffer_load_dwordx4 v95, s[12:15], s33 offen offset:3072  lds
    s_add_u32 m0, m0, 4096
    s_add_u32 s33, s33, 196608
    buffer_load_dwordx4 v92, s[12:15], s33 offen offset:0  lds
    buffer_load_dwordx4 v93, s[12:15], s33 offen offset:1024  lds
    buffer_load_dwordx4 v94, s[12:15], s33 offen offset:2048  lds
    buffer_load_dwordx4 v95, s[12:15], s33 offen offset:3072  lds
    s_mov_b32 s96, s78
    s_mov_b32 s97, s79
    s_add_u32 s78, s78, 1
    s_and_b32 s78, s78, 15
    s_add_u32 s79, s79, 40960
    s_cmp_eq_u32 s79, 163840
    s_cselect_b32 s79, 0, s79
    s_add_u32 s80, s80, 1
    s_cmp_lt_u32 s80, 16
    s_cbranch_scc1 L_lp0
    s_add_u32 m0, s97, s99
    s_lshl_b32 s32, s96, 7
    s_add_u32 s32, s32, s91
    buffer_load_dwordx4 v88, s[8:11], s32 offen offset:0 lds
    buffer_load_dwordx4 v89, s[8:11], s32 offen offset:1024 lds
    buffer_load_dwordx4 v90, s[8:11], s32 offen offset:2048 lds
    s_waitcnt lgkmcnt(0)
    s_waitcnt vmcnt(28)
    s_barrier
    s_mov_b32 s58, 0x800
    s_mov_b32 s59, 0x20000
    s_mov_b32 s62, 0x800
    s_mov_b32 s63, 0x20000
    s_mov_b32 s38, 0x200000
    s_mov_b32 s39, 0x20000
    s_mov_b32 s42, 0x400000
    s_mov_b32 s43, 0x20000
    s_mov_b32 s46, 0x700000
    s_mov_b32 s47, 0x20000
    s_mov_b32 s50, 0x700000
    s_mov_b32 s51, 0x20000
    s_mov_b32 s54, 0x700000
    s_mov_b32 s55, 0x20000
    s_and_b32 s29, s4, 7
    s_lshr_b32 s5, s4, 3
    s_lshl_b32 s28, s3, 2
    s_add_u32 s28, s28, s5
    s_and_b32 s23, s22, 1
    s_bfe_u32 s24, s22, 0x10001
    s_lshl_b32 s35, s22, 12
    s_lshl_b32 s34, s20, 19
    s_getreg_b32 s72, hwreg(HW_REG_XCC_ID, 0, 16)
    s_cmp_gt_u32 s20, 3
    s_subb_u32 s5, s20, 0
    s_cmp_gt_u32 s20, 11
    s_subb_u32 s5, s5, 0
    s_and_b32 s93, s20, 7
    s_cmp_eq_u32 s93, 3
    s_cselect_b32 s5, 14, s5
    s_lshl_b32 s5, s5, 4
    s_add_u32 s93, s5, s21
    v_lshlrev_b32 v1, 4, v0
    v_add_u32 v2, s35, v1
    s_lshl_b32 s6, s24, 14
    v_add_u32 v3, s6, v1
    v_add_u32 v6, 65536, v3
    v_add_u32 v7, 131072, v3
    v_bfe_i32 v82, v0, 2, 1
    v_and_b32 v18, 0x3f803f80, v82
    v_xor_b32 v16, 0x3f803f80, v18
    v_mov_b32 v17, v16
    v_mov_b32 v19, v18
    v_lshrrev_b32 v82, 2, v0
    v_lshlrev_b32 v82, 11, v82
    v_and_b32 v83, 3, v0
    v_lshl_add_u32 v82, v83, 4, v82
    s_lshl_b32 s6, s29, 8
    s_and_b32 s7, s22, 3
    s_lshl_b32 s7, s7, 6
    s_add_u32 s6, s6, s7
    v_add_u32 v28, s6, v82
    s_lshr_b32 s7, s22, 2
    s_lshl_b32 s7, s7, 20
    v_add_u32 v24, s7, v28
    v_bfe_u32 v82, v0, 2, 2
    v_lshrrev_b32 v83, 5, v0
    v_lshl_add_u32 v82, v83, 2, v82
    v_lshlrev_b32 v82, 6, v82
    v_bfe_u32 v83, v0, 4, 1
    v_lshl_add_u32 v82, v83, 5, v82
    v_and_b32 v83, 3, v0
    v_lshl_add_u32 v82, v83, 3, v82
    s_lshl_b32 s6, s22, 10
    s_add_u32 s6, s6, 98304
    v_add_u32 v25, s6, v82
    s_lshl_b32 s77, s22, 10
    s_mul_hi_u32 s5, s93, 0x924924A
    s_mul_i32 s6, s5, 28
    s_sub_u32 s6, s93, s6
    s_mul_i32 s5, s5, 917504
    s_lshl_b32 s6, s6, 8
    s_add_u32 s5, s5, s6
    s_and_b32 s7, s22, 3
    s_lshl_b32 s6, s7, 6
    s_add_u32 s5, s5, s6
    v_lshrrev_b32 v82, 2, v0
    v_mul_u32_u24 v82, 7168, v82
    v_and_b32 v83, 3, v0
    v_lshl_add_u32 v82, v83, 4, v82
    v_add_u32 v120, s5, v82
    v_and_b32 v82, 1, v0
    v_mul_u32_u24 v82, 10, v82
    v_add_u32 v82, 4, v82
    s_mov_b32 s5, 0x11111111
    v_mul_lo_u32 v127, v82, s5
    v_mov_b32 v20, 0
    v_mov_b32 v21, 0
    v_mov_b32 v22, 0
    v_mov_b32 v23, 0
    s_cmp_lt_u32 s22, 4
    s_cselect_b32 s68, s44, s48
    s_cselect_b32 s69, s45, s49
    s_mov_b32 s70, 0x700000
    s_mov_b32 s71, 0x20000
    s_lshl_b32 s5, s22, 6
    v_add_u32 v121, s5, v0
    v_min_u32 v121, 111, v121
    s_mul_i32 s5, s28, 112
    v_add_u32 v122, s5, v121
    v_lshlrev_b32 v122, 3, v122
    v_lshlrev_b32 v121, 1, v121
    v_add_u32 v121, 98816, v121
    v_lshrrev_b32 v123, 5, v0
    v_lshlrev_b32 v123, 3, v123
    s_lshr_b32 s7, s22, 2
    s_lshl_b32 s5, s7, 7
    s_add_u32 s5, s5, 98816
    v_add_u32 v124, s5, v123
    v_lshlrev_b32 v26, 2, v0
    v_add_u32 v26, 99328, v26
    v_mov_b32 v82, 98576
    v_cmp_eq_u32 vcc, 0, v0
    v_mov_b32 v27, 1
    s_nop 0
    v_cndmask_b32 v26, v26, v82, vcc
    s_mul_hi_u32 s5, s93, 0x924924A
    s_mul_i32 s6, s5, 28
    s_sub_u32 s6, s93, s6
    s_lshr_b32 s7, s22, 2
    s_lshl_b32 s44, s7, 3
    s_add_u32 s5, s5, s44
    s_mul_i32 s5, s5, 28672
    s_lshl_b32 s6, s6, 10
    s_add_u32 s5, s5, s6
    s_and_b32 s6, s22, 3
    s_lshl_b32 s6, s6, 8
    s_add_u32 s5, s5, s6
    s_add_u32 s5, s5, 0x1010000
    s_cmp_ge_u32 s93, 224
    s_cselect_b32 s44, 0x80000000, s5
    s_lshl_b32 s5, s28, 1
    s_add_u32 s5, s5, s7
    s_lshl_b32 s49, s5, 16
    s_lshl_b32 s5, s5, 13
    s_add_u32 s5, s5, s6
    s_lshl_b32 s6, s29, 10
    s_add_u32 s5, s5, s6
    s_add_u32 s45, s5, 0x1090000
    s_mul_i32 s46, s28, 229376
    s_lshl_b32 s5, s7, 17
    s_add_u32 s46, s46, s5
    s_lshl_b32 s47, s29, 3
    s_add_u32 s47, s47, s22
    s_lshl_b32 s47, s47, 5
    s_mul_i32 s5, s22, 57344
    s_mul_i32 s6, s28, 896
    s_add_u32 s5, s5, s6
    s_add_u32 s48, s5, 0x1010000
    s_lshl_b32 s5, s23, 1
    s_lshr_b32 s6, s22, 2
    s_add_u32 s5, s5, s6
    s_lshl_b32 s6, s21, 2
    s_add_u32 s5, s5, s6
    s_lshl_b32 s5, s5, 5
    s_lshl_b32 s6, s20, 1
    s_add_u32 s6, s6, s24
    s_add_u32 s5, s5, s6
    s_lshl_b32 s73, s5, 11
    s_add_u32 s73, s73, 0xc00000
    s_lshl_b32 s5, s5, 7
    s_add_u32 s95, s5, 0x1200000
    s_lshr_b32 s7, s22, 2
    s_and_b32 s6, s22, 3
    s_lshl_b32 s5, s7, 4
    s_add_u32 s5, s5, s6
    s_lshl_b32 s31, s28, 6
    s_add_u32 s31, s31, s5
    s_lshl_b32 s30, s31, 11
    s_add_u32 s30, s30, 0xc00000
    s_lshl_b32 s31, s31, 7
    s_add_u32 s31, s31, 0x1200000
    s_lshl_b32 s84, s7, 14
    s_lshl_b32 s5, s6, 11
    s_add_u32 s84, s84, s5
    s_waitcnt vmcnt(14)
    s_barrier
    s_waitcnt vmcnt(0)
    s_barrier
L_ptail:
    s_waitcnt lgkmcnt(0)
    s_lshl_b32 s6, s22, 11
    s_add_u32 s6, s6, 24576
    v_add_u32 v4, s6, v1
    v_mov_b32 v5, 98560
    s_lshl_b32 s5, s20, 8
    s_add_u32 s5, s5, 0x1008000
    s_barrier
    ds_read_b32 v98, v5 offset:8
    ds_read_b128 v[8:11], v4
    ds_read_b128 v[12:15], v4 offset:1024
    s_branch L_p2
L_help:
    s_setprio 3
    s_lshl_b32 s5, s65, 1
    s_add_u32 s5, s5, s4
    s_and_b32 s5, s5, 31
    s_mul_i32 s5, s5, 196608
    s_lshl_b32 s6, s94, 8
    s_add_u32 s92, s5, s6
    v_mul_u32_u24 v94, 6144, v2
    v_bfe_u32 v95, v0, 1, 2
    v_min_u32 v95, 2, v95
    v_lshl_add_u32 v94, v95, 11, v94
    v_and_b32 v95, 1, v0
    v_lshl_add_u32 v94, v95, 7, v94
    s_lshr_b32 s76, s4, 1
    s_waitcnt lgkmcnt(0)
    s_sub_u32 s5, s76, 0
    s_cmp_gt_u32 s5, 4
    s_cbranch_scc1 Lwt_1
    buffer_load_dword v125, v94, s[12:15], s92 offen
    s_add_u32 s92, s92, 49152
    buffer_load_dword v125, v94, s[12:15], s92 offen
    s_add_u32 s92, s92, 49152
    buffer_load_dword v125, v94, s[12:15], s92 offen
    s_add_u32 s92, s92, 49152
    buffer_load_dword v125, v94, s[12:15], s92 offen
Lwt_1:
    s_mov_b32 s58, 0x800
    s_mov_b32 s59, 0x20000
    s_mov_b32 s62, 0x800
    s_mov_b32 s63, 0x20000
    s_mov_b32 s38, 0x200000
    s_mov_b32 s39, 0x20000
    s_mov_b32 s42, 0x400000
    s_mov_b32 s43, 0x20000
    s_mov_b32 s46, 0x700000
    s_mov_b32 s47, 0x20000
    s_mov_b32 s50, 0x700000
    s_mov_b32 s51, 0x20000
    s_mov_b32 s54, 0x700000
    s_mov_b32 s55, 0x20000
    s_and_b32 s29, s4, 7
    s_lshr_b32 s5, s4, 3
    s_lshl_b32 s28, s3, 2
    s_add_u32 s28, s28, s5
    s_and_b32 s23, s22, 1
    s_bfe_u32 s24, s22, 0x10001
    s_lshl_b32 s35, s22, 12
    s_lshl_b32 s34, s20, 19
    s_getreg_b32 s72, hwreg(HW_REG_XCC_ID, 0, 16)
    s_cmp_gt_u32 s20, 3
    s_subb_u32 s5, s20, 0
    s_cmp_gt_u32 s20, 11
    s_subb_u32 s5, s5, 0
    s_and_b32 s93, s20, 7
    s_cmp_eq_u32 s93, 3
    s_cselect_b32 s5, 14, s5
    s_lshl_b32 s5, s5, 4
    s_add_u32 s93, s5, s21
    v_lshlrev_b32 v1, 4, v0
    v_add_u32 v2, s35, v1
    s_lshl_b32 s6, s24, 14
    v_add_u32 v3, s6, v1
    v_add_u32 v6, 65536, v3
    v_add_u32 v7, 131072, v3
    v_bfe_i32 v82, v0, 2, 1
    v_and_b32 v18, 0x3f803f80, v82
    v_xor_b32 v16, 0x3f803f80, v18
    v_mov_b32 v17, v16
    v_mov_b32 v19, v18
    v_lshrrev_b32 v82, 2, v0
    v_lshlrev_b32 v82, 11, v82
    v_and_b32 v83, 3, v0
    v_lshl_add_u32 v82, v83, 4, v82
    s_lshl_b32 s6, s29, 8
    s_and_b32 s7, s22, 3
    s_lshl_b32 s7, s7, 6
    s_add_u32 s6, s6, s7
    v_add_u32 v28, s6, v82
    s_lshr_b32 s7, s22, 2
    s_lshl_b32 s7, s7, 20
    v_add_u32 v24, s7, v28
    v_bfe_u32 v82, v0, 2, 2
    v_lshrrev_b32 v83, 5, v0
    v_lshl_add_u32 v82, v83, 2, v82
    v_lshlrev_b32 v82, 6, v82
    v_bfe_u32 v83, v0, 4, 1
    v_lshl_add_u32 v82, v83, 5, v82
    v_and_b32 v83, 3, v0
    v_lshl_add_u32 v82, v83, 3, v82
    s_lshl_b32 s6, s22, 10
    s_add_u32 s6, s6, 98304
    v_add_u32 v25, s6, v82
    s_lshl_b32 s77, s22, 10
    s_mul_hi_u32 s5, s93, 0x924924A
    s_mul_i32 s6, s5, 28
    s_sub_u32 s6, s93, s6
    s_mul_i32 s5, s5, 917504
    s_lshl_b32 s6, s6, 8
    s_add_u32 s5, s5, s6
    s_and_b32 s7, s22, 3
    s_lshl_b32 s6, s7, 6
    s_add_u32 s5, s5, s6
    v_lshrrev_b32 v82, 2, v0
    v_mul_u32_u24 v82, 7168, v82
    v_and_b32 v83, 3, v0
    v_lshl_add_u32 v82, v83, 4, v82
    v_add_u32 v120, s5, v82
    v_and_b32 v82, 1, v0
    v_mul_u32_u24 v82, 10, v82
    v_add_u32 v82, 4, v82
    s_mov_b32 s5, 0x11111111
    v_mul_lo_u32 v127, v82, s5
    v_mov_b32 v20, 0
    v_mov_b32 v21, 0
    v_mov_b32 v22, 0
    v_mov_b32 v23, 0
    s_cmp_lt_u32 s22, 4
    s_cselect_b32 s68, s44, s48
    s_cselect_b32 s69, s45, s49
    s_mov_b32 s70, 0x700000
    s_mov_b32 s71, 0x20000
    s_lshl_b32 s5, s22, 6
    v_add_u32 v121, s5, v0
    v_min_u32 v121, 111, v121
    s_mul_i32 s5, s28, 112
    v_add_u32 v122, s5, v121
    v_lshlrev_b32 v122, 3, v122
    v_lshlrev_b32 v121, 1, v121
    v_add_u32 v121, 98816, v121
    v_lshrrev_b32 v123, 5, v0
    v_lshlrev_b32 v123, 3, v123
    s_lshr_b32 s7, s22, 2
    s_lshl_b32 s5, s7, 7
    s_add_u32 s5, s5, 98816
    v_add_u32 v124, s5, v123
    v_lshlrev_b32 v26, 2, v0
    v_add_u32 v26, 99328, v26
    v_mov_b32 v82, 98576
    v_cmp_eq_u32 vcc, 0, v0
    v_mov_b32 v27, 1
    s_nop 0
    v_cndmask_b32 v26, v26, v82, vcc
    s_mul_hi_u32 s5, s93, 0x924924A
    s_mul_i32 s6, s5, 28
    s_sub_u32 s6, s93, s6
    s_lshr_b32 s7, s22, 2
    s_lshl_b32 s44, s7, 3
    s_add_u32 s5, s5, s44
    s_mul_i32 s5, s5, 28672
    s_lshl_b32 s6, s6, 10
    s_add_u32 s5, s5, s6
    s_and_b32 s6, s22, 3
    s_lshl_b32 s6, s6, 8
    s_add_u32 s5, s5, s6
    s_add_u32 s5, s5, 0x1010000
    s_cmp_ge_u32 s93, 224
    s_cselect_b32 s44, 0x80000000, s5
    s_lshl_b32 s5, s28, 1
    s_add_u32 s5, s5, s7
    s_lshl_b32 s49, s5, 16
    s_lshl_b32 s5, s5, 13
    s_add_u32 s5, s5, s6
    s_lshl_b32 s6, s29, 10
    s_add_u32 s5, s5, s6
    s_add_u32 s45, s5, 0x1090000
    s_mul_i32 s46, s28, 229376
    s_lshl_b32 s5, s7, 17
    s_add_u32 s46, s46, s5
    s_lshl_b32 s47, s29, 3
    s_add_u32 s47, s47, s22
    s_lshl_b32 s47, s47, 5
    s_mul_i32 s5, s22, 57344
    s_mul_i32 s6, s28, 896
    s_add_u32 s5, s5, s6
    s_add_u32 s48, s5, 0x1010000
    s_lshl_b32 s5, s23, 1
    s_lshr_b32 s6, s22, 2
    s_add_u32 s5, s5, s6
    s_lshl_b32 s6, s21, 2
    s_add_u32 s5, s5, s6
    s_lshl_b32 s5, s5, 5
    s_lshl_b32 s6, s20, 1
    s_add_u32 s6, s6, s24
    s_add_u32 s5, s5, s6
    s_lshl_b32 s73, s5, 11
    s_add_u32 s73, s73, 0xc00000
    s_lshl_b32 s5, s5, 7
    s_add_u32 s95, s5, 0x1200000
    s_lshr_b32 s7, s22, 2
    s_and_b32 s6, s22, 3
    s_lshl_b32 s5, s7, 4
    s_add_u32 s5, s5, s6
    s_lshl_b32 s31, s28, 6
    s_add_u32 s31, s31, s5
    s_lshl_b32 s30, s31, 11
    s_add_u32 s30, s30, 0xc00000
    s_lshl_b32 s31, s31, 7
    s_add_u32 s31, s31, 0x1200000
    s_lshl_b32 s84, s7, 14
    s_lshl_b32 s5, s6, 11
    s_add_u32 s84, s84, s5
    s_lshl_b32 s96, s21, 7
    s_lshl_b32 s5, s20, 3
    s_add_u32 s96, s96, s5
    s_mov_b32 s32, 0x1000000
    v_mov_b32 v4, 0
    buffer_load_dword v81, v4, s[16:19], s32 offen sc1
    v_lshrrev_b32 v4, 3, v0
    v_add_u32 v4, s5, v4
    v_bfe_u32 v5, v4, 1, 3
    v_and_b32 v80, 7, v0
    v_xor_b32 v5, v5, v80
    v_lshlrev_b32 v79, 4, v5
    v_lshlrev_b32 v4, 7, v4
    v_lshl_add_u32 v80, v80, 4, v4
    v_add_u32 v78, 81920, v80
    v_mov_b32 v56, 0
    v_mov_b32 v57, 0
    s_add_u32 s5, s65, 0
    s_and_b32 s5, s5, 15
    s_lshl_b32 s5, s5, 7
    buffer_load_dwordx4 v[128:131], v79, s[56:59], s5 offen
    buffer_load_dwordx4 v[132:135], v79, s[60:63], s5 offen
    s_add_u32 s5, s65, 1
    s_and_b32 s5, s5, 15
    s_lshl_b32 s5, s5, 7
    buffer_load_dwordx4 v[136:139], v79, s[56:59], s5 offen
    buffer_load_dwordx4 v[140:143], v79, s[60:63], s5 offen
    s_add_u32 s5, s65, 2
    s_and_b32 s5, s5, 15
    s_lshl_b32 s5, s5, 7
    buffer_load_dwordx4 v[144:147], v79, s[56:59], s5 offen
    buffer_load_dwordx4 v[148:151], v79, s[60:63], s5 offen
    s_barrier
    v_lshrrev_b32 v4, 2, v0
    v_and_b32 v4, 7, v4
    v_and_b32 v5, 3, v0
    v_lshlrev_b32 v4, 11, v4
    v_lshl_add_u32 v4, v5, 7, v4
    s_lshl_b32 s5, s2, 14
    s_mov_b32 exec_hi, 0
    buffer_load_dword v125, v4, s[8:11], s5 offen offset:1024
    s_mov_b32 exec_hi, -1
    s_cmp_lg_u32 s76, 5
    s_cbranch_scc1 Lwt_2
    buffer_load_dword v125, v94, s[12:15], s92 offen
    s_add_u32 s92, s92, 49152
    buffer_load_dword v125, v94, s[12:15], s92 offen
    s_add_u32 s92, s92, 49152
    buffer_load_dword v125, v94, s[12:15], s92 offen
    s_add_u32 s92, s92, 49152
    buffer_load_dword v125, v94, s[12:15], s92 offen
Lwt_2:
    ds_read_b128 v[48:51], v80 offset:0
    s_add_u32 s5, s65, 3
    s_and_b32 s5, s5, 15
    s_lshl_b32 s5, s5, 7
    buffer_load_dwordx4 v[152:155], v79, s[56:59], s5 offen
    buffer_load_dwordx4 v[156:159], v79, s[60:63], s5 offen
    s_waitcnt lgkmcnt(0)
    s_barrier
    v_lshrrev_b32 v4, 2, v0
    v_and_b32 v4, 7, v4
    v_and_b32 v5, 3, v0
    v_lshlrev_b32 v4, 11, v4
    v_lshl_add_u32 v4, v5, 7, v4
    s_lshl_b32 s5, s2, 14
    s_mov_b32 exec_hi, 0
    buffer_load_dword v125, v4, s[8:11], s5 offen offset:1536
    s_mov_b32 exec_hi, -1
    s_cmp_lg_u32 s76, 6
    s_cbranch_scc1 Lwt_3
    buffer_load_dword v125, v94, s[12:15], s92 offen
    s_add_u32 s92, s92, 49152
    buffer_load_dword v125, v94, s[12:15], s92 offen
    s_add_u32 s92, s92, 49152
    buffer_load_dword v125, v94, s[12:15], s92 offen
    s_add_u32 s92, s92, 49152
    buffer_load_dword v125, v94, s[12:15], s92 offen
Lwt_3:
    ds_read_b128 v[52:55], v80 offset:40960
    s_add_u32 s5, s65, 4
    s_and_b32 s5, s5, 15
    s_lshl_b32 s5, s5, 7
    buffer_load_dwordx4 v[160:163], v79, s[56:59], s5 offen
    buffer_load_dwordx4 v[164:167], v79, s[60:63], s5 offen
    s_waitcnt vmcnt(11)
    v_dot2c_f32_bf16 v56, v48, v128
    s_waitcnt vmcnt(10)
    v_dot2c_f32_bf16 v57, v48, v132
    v_dot2c_f32_bf16 v56, v49, v129
    v_dot2c_f32_bf16 v57, v49, v133
    v_dot2c_f32_bf16 v56, v50, v130
    v_dot2c_f32_bf16 v57, v50, v134
    v_dot2c_f32_bf16 v56, v51, v131
    v_dot2c_f32_bf16 v57, v51, v135
    s_waitcnt lgkmcnt(0)
    s_barrier
    s_cmp_lg_u32 s76, 7
    s_cbranch_scc1 Lwt_4
    buffer_load_dword v125, v94, s[12:15], s92 offen
    s_add_u32 s92, s92, 49152
    buffer_load_dword v125, v94, s[12:15], s92 offen
    s_add_u32 s92, s92, 49152
    buffer_load_dword v125, v94, s[12:15], s92 offen
    s_add_u32 s92, s92, 49152
    buffer_load_dword v125, v94, s[12:15], s92 offen
Lwt_4:
    ds_read_b128 v[48:51], v78 offset:0
    s_add_u32 s5, s65, 5
    s_and_b32 s5, s5, 15
    s_lshl_b32 s5, s5, 7
    buffer_load_dwordx4 v[168:171], v79, s[56:59], s5 offen
    buffer_load_dwordx4 v[172:175], v79, s[60:63], s5 offen
    s_waitcnt vmcnt(11)
    v_dot2c_f32_bf16 v56, v52, v136
    s_waitcnt vmcnt(10)
    v_dot2c_f32_bf16 v57, v52, v140
    v_dot2c_f32_bf16 v56, v53, v137
    v_dot2c_f32_bf16 v57, v53, v141
    v_dot2c_f32_bf16 v56, v54, v138
    v_dot2c_f32_bf16 v57, v54, v142
    v_dot2c_f32_bf16 v56, v55, v139
    v_dot2c_f32_bf16 v57, v55, v143
    s_waitcnt lgkmcnt(0)
    s_barrier
    s_cmp_lg_u32 s76, 8
    s_cbranch_scc1 Lwt_5
    buffer_load_dword v125, v94, s[12:15], s92 offen
    s_add_u32 s92, s92, 49152
    buffer_load_dword v125, v94, s[12:15], s92 offen
    s_add_u32 s92, s92, 49152
    buffer_load_dword v125, v94, s[12:15], s92 offen
    s_add_u32 s92, s92, 49152
    buffer_load_dword v125, v94, s[12:15], s92 offen
Lwt_5:
    ds_read_b128 v[52:55], v78 offset:40960
    s_add_u32 s5, s65, 6
    s_and_b32 s5, s5, 15
    s_lshl_b32 s5, s5, 7
    buffer_load_dwordx4 v[176:179], v79, s[56:59], s5 offen
    buffer_load_dwordx4 v[180:183], v79, s[60:63], s5 offen
    s_waitcnt vmcnt(11)
    v_dot2c_f32_bf16 v56, v48, v144
    s_waitcnt vmcnt(10)
    v_dot2c_f32_bf16 v57, v48, v148
    v_dot2c_f32_bf16 v56, v49, v145
    v_dot2c_f32_bf16 v57, v49, v149
    v_dot2c_f32_bf16 v56, v50, v146
    v_dot2c_f32_bf16 v57, v50, v150
    v_dot2c_f32_bf16 v56, v51, v147
    v_dot2c_f32_bf16 v57, v51, v151
    s_waitcnt lgkmcnt(0)
    v_readfirstlane_b32 s25, v81
    s_nop 3
    s_mul_i32 s25, s25, 0x9E3779B1
    s_add_u32 s25, s25, 0x7F4A7C15
    v_mov_b32 v82, s72
    v_mov_b32 v83, s25
    v_mov_b32 v4, 0
    s_lshl_b32 s7, s20, 4
    s_add_u32 s7, s7, s21
    s_lshl_b32 s7, s7, 3
    s_add_u32 s7, s7, 0x1009000
    s_mov_b64 exec, 1
    buffer_store_dwordx2 v[82:83], v4, s[16:19], s7 offen sc1
    s_mov_b64 exec, -1
    s_barrier
    s_cmp_lg_u32 s76, 9
    s_cbranch_scc1 Lwt_6
    buffer_load_dword v125, v94, s[12:15], s92 offen
    s_add_u32 s92, s92, 49152
    buffer_load_dword v125, v94, s[12:15], s92 offen
    s_add_u32 s92, s92, 49152
    buffer_load_dword v125, v94, s[12:15], s92 offen
    s_add_u32 s92, s92, 49152
    buffer_load_dword v125, v94, s[12:15], s92 offen
Lwt_6:
    ds_read_b128 v[48:51], v80 offset:0
    s_add_u32 s5, s65, 7
    s_and_b32 s5, s5, 15
    s_lshl_b32 s5, s5, 7
    buffer_load_dwordx4 v[184:187], v79, s[56:59], s5 offen
    buffer_load_dwordx4 v[188:191], v79, s[60:63], s5 offen
    s_waitcnt vmcnt(11)
    v_dot2c_f32_bf16 v56, v52, v152
    s_waitcnt vmcnt(10)
    v_dot2c_f32_bf16 v57, v52, v156
    v_dot2c_f32_bf16 v56, v53, v153
    v_dot2c_f32_bf16 v57, v53, v157
    v_dot2c_f32_bf16 v56, v54, v154
    v_dot2c_f32_bf16 v57, v54, v158
    v_dot2c_f32_bf16 v56, v55, v155
    v_dot2c_f32_bf16 v57, v55, v159
    s_waitcnt lgkmcnt(0)
    s_barrier
    s_cmp_lg_u32 s76, 10
    s_cbranch_scc1 Lwt_7
    buffer_load_dword v125, v94, s[12:15], s92 offen
    s_add_u32 s92, s92, 49152
    buffer_load_dword v125, v94, s[12:15], s92 offen
    s_add_u32 s92, s92, 49152
    buffer_load_dword v125, v94, s[12:15], s92 offen
    s_add_u32 s92, s92, 49152
    buffer_load_dword v125, v94, s[12:15], s92 offen
Lwt_7:
    ds_read_b128 v[52:55], v80 offset:40960
    s_add_u32 s5, s65, 8
    s_and_b32 s5, s5, 15
    s_lshl_b32 s5, s5, 7
    buffer_load_dwordx4 v[192:195], v79, s[56:59], s5 offen
    buffer_load_dwordx4 v[196:199], v79, s[60:63], s5 offen
    s_waitcnt vmcnt(10)
    v_dot2c_f32_bf16 v56, v48, v160
    s_waitcnt vmcnt(9)
    v_dot2c_f32_bf16 v57, v48, v164
    v_dot2c_f32_bf16 v56, v49, v161
    v_dot2c_f32_bf16 v57, v49, v165
    v_dot2c_f32_bf16 v56, v50, v162
    v_dot2c_f32_bf16 v57, v50, v166
    v_dot2c_f32_bf16 v56, v51, v163
    v_dot2c_f32_bf16 v57, v51, v167
    s_waitcnt lgkmcnt(0)
    s_barrier
    s_cmp_lg_u32 s76, 11
    s_cbranch_scc1 Lwt_8
    buffer_load_dword v125, v94, s[12:15], s92 offen
    s_add_u32 s92, s92, 49152
    buffer_load_dword v125, v94, s[12:15], s92 offen
    s_add_u32 s92, s92, 49152
    buffer_load_dword v125, v94, s[12:15], s92 offen
    s_add_u32 s92, s92, 49152
    buffer_load_dword v125, v94, s[12:15], s92 offen
Lwt_8:
    ds_read_b128 v[48:51], v78 offset:0
    s_add_u32 s5, s65, 9
    s_and_b32 s5, s5, 15
    s_lshl_b32 s5, s5, 7
    buffer_load_dwordx4 v[200:203], v79, s[56:59], s5 offen
    buffer_load_dwordx4 v[204:207], v79, s[60:63], s5 offen
    s_waitcnt vmcnt(10)
    v_dot2c_f32_bf16 v56, v52, v168
    s_waitcnt vmcnt(9)
    v_dot2c_f32_bf16 v57, v52, v172
    v_dot2c_f32_bf16 v56, v53, v169
    v_dot2c_f32_bf16 v57, v53, v173
    v_dot2c_f32_bf16 v56, v54, v170
    v_dot2c_f32_bf16 v57, v54, v174
    v_dot2c_f32_bf16 v56, v55, v171
    v_dot2c_f32_bf16 v57, v55, v175
    s_waitcnt lgkmcnt(0)
    s_barrier
    s_cmp_lg_u32 s76, 12
    s_cbranch_scc1 Lwt_9
    buffer_load_dword v125, v94, s[12:15], s92 offen
    s_add_u32 s92, s92, 49152
    buffer_load_dword v125, v94, s[12:15], s92 offen
    s_add_u32 s92, s92, 49152
    buffer_load_dword v125, v94, s[12:15], s92 offen
    s_add_u32 s92, s92, 49152
    buffer_load_dword v125, v94, s[12:15], s92 offen
Lwt_9:
    ds_read_b128 v[52:55], v78 offset:40960
    s_add_u32 s5, s65, 10
    s_and_b32 s5, s5, 15
    s_lshl_b32 s5, s5, 7
    buffer_load_dwordx4 v[208:211], v79, s[56:59], s5 offen
    buffer_load_dwordx4 v[212:215], v79, s[60:63], s5 offen
    s_waitcnt vmcnt(10)
    v_dot2c_f32_bf16 v56, v48, v176
    s_waitcnt vmcnt(9)
    v_dot2c_f32_bf16 v57, v48, v180
    v_dot2c_f32_bf16 v56, v49, v177
    v_dot2c_f32_bf16 v57, v49, v181
    v_dot2c_f32_bf16 v56, v50, v178
    v_dot2c_f32_bf16 v57, v50, v182
    v_dot2c_f32_bf16 v56, v51, v179
    v_dot2c_f32_bf16 v57, v51, v183
    s_waitcnt lgkmcnt(0)
    s_barrier
    s_cmp_lg_u32 s76, 13
    s_cbranch_scc1 Lwt_10
    buffer_load_dword v125, v94, s[12:15], s92 offen
    s_add_u32 s92, s92, 49152
    buffer_load_dword v125, v94, s[12:15], s92 offen
    s_add_u32 s92, s92, 49152
    buffer_load_dword v125, v94, s[12:15], s92 offen
    s_add_u32 s92, s92, 49152
    buffer_load_dword v125, v94, s[12:15], s92 offen
Lwt_10:
    ds_read_b128 v[48:51], v80 offset:0
    s_add_u32 s5, s65, 11
    s_and_b32 s5, s5, 15
    s_lshl_b32 s5, s5, 7
    buffer_load_dwordx4 v[216:219], v79, s[56:59], s5 offen
    buffer_load_dwordx4 v[220:223], v79, s[60:63], s5 offen
    s_waitcnt vmcnt(9)
    v_dot2c_f32_bf16 v56, v52, v184
    s_waitcnt vmcnt(8)
    v_dot2c_f32_bf16 v57, v52, v188
    v_dot2c_f32_bf16 v56, v53, v185
    v_dot2c_f32_bf16 v57, v53, v189
    v_dot2c_f32_bf16 v56, v54, v186
    v_dot2c_f32_bf16 v57, v54, v190
    v_dot2c_f32_bf16 v56, v55, v187
    v_dot2c_f32_bf16 v57, v55, v191
    s_waitcnt lgkmcnt(0)
    s_barrier
    s_cmp_lg_u32 s76, 14
    s_cbranch_scc1 Lwt_11
    buffer_load_dword v125, v94, s[12:15], s92 offen
    s_add_u32 s92, s92, 49152
    buffer_load_dword v125, v94, s[12:15], s92 offen
    s_add_u32 s92, s92, 49152
    buffer_load_dword v125, v94, s[12:15], s92 offen
    s_add_u32 s92, s92, 49152
    buffer_load_dword v125, v94, s[12:15], s92 offen
Lwt_11:
    ds_read_b128 v[52:55], v80 offset:40960
    s_add_u32 s5, s65, 12
    s_and_b32 s5, s5, 15
    s_lshl_b32 s5, s5, 7
    buffer_load_dwordx4 v[224:227], v79, s[56:59], s5 offen
    buffer_load_dwordx4 v[228:231], v79, s[60:63], s5 offen
    s_waitcnt vmcnt(9)
    v_dot2c_f32_bf16 v56, v48, v192
    s_waitcnt vmcnt(8)
    v_dot2c_f32_bf16 v57, v48, v196
    v_dot2c_f32_bf16 v56, v49, v193
    v_dot2c_f32_bf16 v57, v49, v197
    v_dot2c_f32_bf16 v56, v50, v194
    v_dot2c_f32_bf16 v57, v50, v198
    v_dot2c_f32_bf16 v56, v51, v195
    v_dot2c_f32_bf16 v57, v51, v199
    s_waitcnt lgkmcnt(0)
    s_barrier
    s_cmp_lg_u32 s76, 15
    s_cbranch_scc1 Lwt_12
    buffer_load_dword v125, v94, s[12:15], s92 offen
    s_add_u32 s92, s92, 49152
    buffer_load_dword v125, v94, s[12:15], s92 offen
    s_add_u32 s92, s92, 49152
    buffer_load_dword v125, v94, s[12:15], s92 offen
    s_add_u32 s92, s92, 49152
    buffer_load_dword v125, v94, s[12:15], s92 offen
Lwt_12:
    ds_read_b128 v[48:51], v78 offset:0
    s_add_u32 s5, s65, 13
    s_and_b32 s5, s5, 15
    s_lshl_b32 s5, s5, 7
    buffer_load_dwordx4 v[232:235], v79, s[56:59], s5 offen
    buffer_load_dwordx4 v[236:239], v79, s[60:63], s5 offen
    s_waitcnt vmcnt(9)
    v_dot2c_f32_bf16 v56, v52, v200
    s_waitcnt vmcnt(8)
    v_dot2c_f32_bf16 v57, v52, v204
    v_dot2c_f32_bf16 v56, v53, v201
    v_dot2c_f32_bf16 v57, v53, v205
    v_dot2c_f32_bf16 v56, v54, v202
    v_dot2c_f32_bf16 v57, v54, v206
    v_dot2c_f32_bf16 v56, v55, v203
    v_dot2c_f32_bf16 v57, v55, v207
    s_waitcnt lgkmcnt(0)
    s_barrier
    ds_read_b128 v[52:55], v78 offset:40960
    s_add_u32 s5, s65, 14
    s_and_b32 s5, s5, 15
    s_lshl_b32 s5, s5, 7
    buffer_load_dwordx4 v[240:243], v79, s[56:59], s5 offen
    buffer_load_dwordx4 v[244:247], v79, s[60:63], s5 offen
    s_waitcnt vmcnt(9)
    v_dot2c_f32_bf16 v56, v48, v208
    s_waitcnt vmcnt(8)
    v_dot2c_f32_bf16 v57, v48, v212
    v_dot2c_f32_bf16 v56, v49, v209
    v_dot2c_f32_bf16 v57, v49, v213
    v_dot2c_f32_bf16 v56, v50, v210
    v_dot2c_f32_bf16 v57, v50, v214
    v_dot2c_f32_bf16 v56, v51, v211
    v_dot2c_f32_bf16 v57, v51, v215
    s_waitcnt lgkmcnt(0)
    s_barrier
    ds_read_b128 v[48:51], v80 offset:0
    s_add_u32 s5, s65, 15
    s_and_b32 s5, s5, 15
    s_lshl_b32 s5, s5, 7
    buffer_load_dwordx4 v[248:251], v79, s[56:59], s5 offen
    buffer_load_dwordx4 v[252:255], v79, s[60:63], s5 offen
    s_waitcnt vmcnt(9)
    v_dot2c_f32_bf16 v56, v52, v216
    s_waitcnt vmcnt(8)
    v_dot2c_f32_bf16 v57, v52, v220
    v_dot2c_f32_bf16 v56, v53, v217
    v_dot2c_f32_bf16 v57, v53, v221
    v_dot2c_f32_bf16 v56, v54, v218
    v_dot2c_f32_bf16 v57, v54, v222
    v_dot2c_f32_bf16 v56, v55, v219
    v_dot2c_f32_bf16 v57, v55, v223
    s_waitcnt lgkmcnt(0)
    v_lshlrev_b32 v4, 7, v0
    s_lshl_b32 s6, s21, 15
    s_add_u32 s6, s6, s34
    buffer_load_dword v125, v4, s[16:19], s6 offen sc1
    v_lshlrev_b32 v4, 7, v0
    s_lshl_b32 s6, s21, 15
    s_add_u32 s6, s6, s34
    s_add_u32 s6, s6, 8192
    buffer_load_dword v125, v4, s[16:19], s6 offen sc1
    s_barrier
    ds_read_b128 v[52:55], v80 offset:40960
    s_waitcnt vmcnt(9)
    v_dot2c_f32_bf16 v56, v48, v224
    s_waitcnt vmcnt(8)
    v_dot2c_f32_bf16 v57, v48, v228
    v_dot2c_f32_bf16 v56, v49, v225
    v_dot2c_f32_bf16 v57, v49, v229
    v_dot2c_f32_bf16 v56, v50, v226
    v_dot2c_f32_bf16 v57, v50, v230
    v_dot2c_f32_bf16 v56, v51, v227
    v_dot2c_f32_bf16 v57, v51, v231
    s_waitcnt lgkmcnt(0)
    v_lshlrev_b32 v4, 7, v0
    s_lshl_b32 s6, s21, 15
    s_add_u32 s6, s6, s34
    s_getpc_b64 s[6:7]
L_pcB:
    s_sub_u32 s6, s6, L_pcB-gated_mix__softmax_full_mha__moe_arch_mod__prompt_kernel
    s_subb_u32 s7, s7, 0
    s_lshr_b32 s5, s2, 3
    s_lshl_b32 s5, s5, 11
    v_and_b32 v4, 15, v0
    v_lshl_add_u32 v4, v4, 7, s5
    v_min_u32 v4, L_end-gated_mix__softmax_full_mha__moe_arch_mod__prompt_kernel, v4
    s_mov_b64 exec, 0xffff
    global_load_dword v125, v4, s[6:7]
    s_mov_b64 exec, -1
Lct_13:
    s_lshl_b32 s5, s20, 8
    s_add_u32 s5, s5, 0x1008000
    v_lshlrev_b32 v4, 2, v0
    buffer_load_dword v125, v4, s[16:19], s5 offen sc1
    v_lshlrev_b32 v4, 7, v0
    s_lshl_b32 s6, s21, 15
    s_add_u32 s6, s6, s34
    s_add_u32 s6, s6, 16384
    buffer_load_dword v125, v4, s[16:19], s6 offen sc1
    v_lshlrev_b32 v4, 7, v0
    s_lshl_b32 s6, s21, 15
    s_add_u32 s6, s6, s34
    s_add_u32 s6, s6, 24576
    buffer_load_dword v125, v4, s[16:19], s6 offen sc1
    s_barrier
    ds_read_b128 v[48:51], v78 offset:0
    s_waitcnt vmcnt(10)
    v_dot2c_f32_bf16 v56, v52, v232
    s_waitcnt vmcnt(9)
    v_dot2c_f32_bf16 v57, v52, v236
    v_dot2c_f32_bf16 v56, v53, v233
    v_dot2c_f32_bf16 v57, v53, v237
    v_dot2c_f32_bf16 v56, v54, v234
    v_dot2c_f32_bf16 v57, v54, v238
    v_dot2c_f32_bf16 v56, v55, v235
    v_dot2c_f32_bf16 v57, v55, v239
    s_waitcnt lgkmcnt(0)
    s_barrier
    ds_read_b128 v[52:55], v78 offset:40960
    s_waitcnt vmcnt(8)
    v_dot2c_f32_bf16 v56, v48, v240
    s_waitcnt vmcnt(7)
    v_dot2c_f32_bf16 v57, v48, v244
    v_dot2c_f32_bf16 v56, v49, v241
    v_dot2c_f32_bf16 v57, v49, v245
    v_dot2c_f32_bf16 v56, v50, v242
    v_dot2c_f32_bf16 v57, v50, v246
    v_dot2c_f32_bf16 v56, v51, v243
    v_dot2c_f32_bf16 v57, v51, v247
    s_waitcnt lgkmcnt(0)
    s_waitcnt vmcnt(6)
    v_dot2c_f32_bf16 v56, v52, v248
    s_waitcnt vmcnt(5)
    v_dot2c_f32_bf16 v57, v52, v252
    v_dot2c_f32_bf16 v56, v53, v249
    v_dot2c_f32_bf16 v57, v53, v253
    v_dot2c_f32_bf16 v56, v54, v250
    v_dot2c_f32_bf16 v57, v54, v254
    v_dot2c_f32_bf16 v56, v55, v251
    v_dot2c_f32_bf16 v57, v55, v255
    s_nop 2
    s_nop 0
    v_add_f32_dpp v56, v56, v56 quad_perm:[1,0,3,2] row_mask:0xf bank_mask:0xf
    v_add_f32_dpp v57, v57, v57 quad_perm:[1,0,3,2] row_mask:0xf bank_mask:0xf
    s_nop 0
    v_add_f32_dpp v56, v56, v56 quad_perm:[2,3,0,1] row_mask:0xf bank_mask:0xf
    v_add_f32_dpp v57, v57, v57 quad_perm:[2,3,0,1] row_mask:0xf bank_mask:0xf
    s_nop 0
    v_add_f32_dpp v56, v56, v56 row_half_mirror row_mask:0xf bank_mask:0xf
    v_add_f32_dpp v57, v57, v57 row_half_mirror row_mask:0xf bank_mask:0xf
    v_cvt_pk_bf16_f32 v57, v57, v57
    v_and_b32 v57, 0xffff0000, v57
    v_mul_f32 v57, 0xbfb8aa3b, v57
    v_exp_f32 v57, v57
    s_nop 0
    v_add_f32 v57, 1.0, v57
    v_rcp_f32 v57, v57
    s_nop 0
    v_cvt_pk_bf16_f32 v57, v57, v57
    v_and_b32 v57, 0xffff0000, v57
    v_cvt_pk_bf16_f32 v56, v56, v56
    v_ashrrev_i32 v4, 31, v56
    v_or_b32 v4, 0x80000000, v4
    v_xor_b32 v56, v56, v4
    v_and_b32 v56, 0xffff0000, v56
    v_lshrrev_b32 v4, 3, v0
    s_sub_u32 s5, 2047, s96
    v_sub_u32 v5, s5, v4
    v_or_b32 v56, v56, v5
    s_nop 1
    v_max_u32_dpp v56, v56, v56 row_shr:1 bound_ctrl:0
    s_nop 1
    v_max_u32_dpp v56, v56, v56 row_shr:2 bound_ctrl:0
    s_nop 1
    v_max_u32_dpp v56, v56, v56 row_shr:4 bound_ctrl:0
    s_nop 1
    v_max_u32_dpp v56, v56, v56 row_shr:8 bound_ctrl:0
    s_nop 1
    v_max_u32_dpp v56, v56, v56 row_bcast:15 row_mask:0xa
    s_nop 1
    v_max_u32_dpp v56, v56, v56 row_bcast:31 row_mask:0xc
    v_mov_b32 v48, v57
    v_mov_b32 v49, s25
    v_mov_b32 v57, s25
    s_lshl_b32 s5, s96, 3
    s_add_u32 s5, s5, 0x1004000
    s_add_u32 s6, s96, 0x1000fc1
    s_mov_b32 exec_lo, 0
    s_mov_b32 exec_hi, 0x80000000
    buffer_store_dwordx2 v[56:57], v0, s[16:19], s6 offen sc1
    s_mov_b32 exec_lo, 0x01010101
    s_mov_b32 exec_hi, 0x01010101
    buffer_store_dwordx2 v[48:49], v0, s[16:19], s5 offen sc1
    s_mov_b64 exec, -1
    s_setprio 0
    v_mov_b32 v86, s25
    v_mov_b32 v87, 0
    v_mov_b32 v4, 98560
    ds_write_b32 v4, v86 offset:8
    ds_write_b32 v4, v87 offset:16
    ds_write_b32 v4, v87 offset:128
    ds_write_b32 v4, v87 offset:132
    ds_write_b32 v4, v87 offset:136
    ds_write_b32 v4, v87 offset:140
    v_lshlrev_b32 v4, 2, v0
    v_add_u32 v4, 98816, v4
    ds_write_b32 v4, v87
    s_branch L_ptail
L_cons:
    s_mov_b32 s58, 0x800
    s_mov_b32 s59, 0x20000
    s_mov_b32 s62, 0x800
    s_mov_b32 s63, 0x20000
    s_mov_b32 s38, 0x200000
    s_mov_b32 s39, 0x20000
    s_mov_b32 s42, 0x400000
    s_mov_b32 s43, 0x20000
    s_mov_b32 s46, 0x700000
    s_mov_b32 s47, 0x20000
    s_mov_b32 s50, 0x700000
    s_mov_b32 s51, 0x20000
    s_mov_b32 s54, 0x700000
    s_mov_b32 s55, 0x20000
    s_and_b32 s29, s4, 7
    s_lshr_b32 s5, s4, 3
    s_lshl_b32 s28, s3, 2
    s_add_u32 s28, s28, s5
    s_and_b32 s23, s22, 1
    s_bfe_u32 s24, s22, 0x10001
    s_lshl_b32 s35, s22, 12
    s_lshl_b32 s34, s20, 19
    s_getreg_b32 s72, hwreg(HW_REG_XCC_ID, 0, 16)
    s_cmp_gt_u32 s20, 3
    s_subb_u32 s5, s20, 0
    s_cmp_gt_u32 s20, 11
    s_subb_u32 s5, s5, 0
    s_and_b32 s93, s20, 7
    s_cmp_eq_u32 s93, 3
    s_cselect_b32 s5, 14, s5
    s_lshl_b32 s5, s5, 4
    s_add_u32 s93, s5, s21
    s_waitcnt lgkmcnt(0)
    s_mov_b32 s32, 0x1000000
    v_mov_b32 v4, 0
    buffer_load_dword v36, v4, s[16:19], s32 offen sc1
    s_cmp_lg_u32 s22, 0
    s_cbranch_scc1 Lct_14
    s_getpc_b64 s[6:7]
L_pcA:
    s_sub_u32 s6, s6, L_pcA-gated_mix__softmax_full_mha__moe_arch_mod__prompt_kernel
    s_subb_u32 s7, s7, 0
    s_lshr_b32 s5, s2, 3
    s_lshl_b32 s5, s5, 11
    v_and_b32 v4, 15, v0
    v_lshl_add_u32 v4, v4, 7, s5
    v_min_u32 v4, L_end-gated_mix__softmax_full_mha__moe_arch_mod__prompt_kernel, v4
    s_mov_b64 exec, 0xffff
    global_load_dword v125, v4, s[6:7]
    s_mov_b64 exec, -1
Lct_14:
    v_and_b32 v4, 15, v0
    v_lshrrev_b32 v5, 4, v0
    v_lshrrev_b32 v29, 1, v4
    s_lshl_b32 s5, s23, 13
    v_lshl_add_u32 v4, v4, 7, s5
    v_or_b32 v30, 0, v5
    v_xor_b32 v30, v30, v29
    v_lshl_add_u32 v8, v30, 4, v4
    v_add_u32 v10, 81920, v8
    v_or_b32 v30, 4, v5
    v_xor_b32 v30, v30, v29
    v_lshl_add_u32 v9, v30, 4, v4
    v_add_u32 v11, 81920, v9
    v_bfe_u32 v29, v0, 2, 2
    v_lshl_add_u32 v4, v5, 3, v29
    v_lshlrev_b32 v4, 7, v4
    v_and_b32 v5, 1, v5
    v_lshlrev_b32 v5, 1, v5
    v_bfe_u32 v30, v0, 1, 1
    v_or_b32 v5, v5, v30
    s_lshl_b32 s5, s24, 2
    v_or_b32 v5, s5, v5
    v_lshrrev_b32 v29, 1, v29
    v_lshlrev_b32 v29, 2, v29
    v_xor_b32 v5, v5, v29
    v_lshl_add_u32 v4, v5, 4, v4
    v_and_b32 v5, 1, v0
    v_lshl_add_u32 v4, v5, 3, v4
    v_add_u32 v12, 16384, v4
    v_xor_b32 v13, 32, v12
    v_add_u32 v14, 81920, v12
    v_add_u32 v15, 81920, v13
    v_lshlrev_b32 v1, 4, v0
    v_add_u32 v2, s35, v1
    s_lshl_b32 s6, s24, 14
    v_add_u32 v3, s6, v1
    v_add_u32 v6, 65536, v3
    v_add_u32 v7, 131072, v3
    v_bfe_i32 v40, v0, 2, 1
    v_and_b32 v18, 0x3f803f80, v40
    v_xor_b32 v16, 0x3f803f80, v18
    v_mov_b32 v17, v16
    v_mov_b32 v19, v18
    v_lshrrev_b32 v40, 2, v0
    v_lshlrev_b32 v40, 11, v40
    v_and_b32 v41, 3, v0
    v_lshl_add_u32 v40, v41, 4, v40
    s_lshl_b32 s6, s29, 8
    s_and_b32 s7, s22, 3
    s_lshl_b32 s7, s7, 6
    s_add_u32 s6, s6, s7
    v_add_u32 v28, s6, v40
    s_lshr_b32 s7, s22, 2
    s_lshl_b32 s7, s7, 20
    v_add_u32 v24, s7, v28
    v_bfe_u32 v40, v0, 2, 2
    v_lshrrev_b32 v41, 5, v0
    v_lshl_add_u32 v40, v41, 2, v40
    v_lshlrev_b32 v40, 6, v40
    v_bfe_u32 v41, v0, 4, 1
    v_lshl_add_u32 v40, v41, 5, v40
    v_and_b32 v41, 3, v0
    v_lshl_add_u32 v40, v41, 3, v40
    s_lshl_b32 s6, s22, 10
    s_add_u32 s6, s6, 98304
    v_add_u32 v25, s6, v40
    s_lshl_b32 s77, s22, 10
    s_mul_hi_u32 s5, s93, 0x924924A
    s_mul_i32 s6, s5, 28
    s_sub_u32 s6, s93, s6
    s_mul_i32 s5, s5, 917504
    s_lshl_b32 s6, s6, 8
    s_add_u32 s5, s5, s6
    s_and_b32 s7, s22, 3
    s_lshl_b32 s6, s7, 6
    s_add_u32 s5, s5, s6
    v_lshrrev_b32 v40, 2, v0
    v_mul_u32_u24 v40, 7168, v40
    v_and_b32 v41, 3, v0
    v_lshl_add_u32 v40, v41, 4, v40
    v_add_u32 v120, s5, v40
    v_and_b32 v40, 1, v0
    v_mul_u32_u24 v40, 10, v40
    v_add_u32 v40, 4, v40
    s_mov_b32 s5, 0x11111111
    v_mul_lo_u32 v127, v40, s5
    v_mov_b32 v20, 0
    v_mov_b32 v21, 0
    v_mov_b32 v22, 0
    v_mov_b32 v23, 0
    s_cmp_lt_u32 s22, 4
    s_cselect_b32 s68, s44, s48
    s_cselect_b32 s69, s45, s49
    s_mov_b32 s70, 0x700000
    s_mov_b32 s71, 0x20000
    s_lshl_b32 s5, s22, 6
    v_add_u32 v121, s5, v0
    v_min_u32 v121, 111, v121
    s_mul_i32 s5, s28, 112
    v_add_u32 v122, s5, v121
    v_lshlrev_b32 v122, 3, v122
    v_lshlrev_b32 v121, 1, v121
    v_add_u32 v121, 98816, v121
    v_lshrrev_b32 v123, 5, v0
    v_lshlrev_b32 v123, 3, v123
    s_lshr_b32 s7, s22, 2
    s_lshl_b32 s5, s7, 7
    s_add_u32 s5, s5, 98816
    v_add_u32 v124, s5, v123
    v_lshlrev_b32 v26, 2, v0
    v_add_u32 v26, 99328, v26
    v_mov_b32 v40, 98576
    v_cmp_eq_u32 vcc, 0, v0
    v_mov_b32 v27, 1
    s_nop 0
    v_cndmask_b32 v26, v26, v40, vcc
    s_mul_hi_u32 s5, s93, 0x924924A
    s_mul_i32 s6, s5, 28
    s_sub_u32 s6, s93, s6
    s_lshr_b32 s7, s22, 2
    s_lshl_b32 s44, s7, 3
    s_add_u32 s5, s5, s44
    s_mul_i32 s5, s5, 28672
    s_lshl_b32 s6, s6, 10
    s_add_u32 s5, s5, s6
    s_and_b32 s6, s22, 3
    s_lshl_b32 s6, s6, 8
    s_add_u32 s5, s5, s6
    s_add_u32 s5, s5, 0x1010000
    s_cmp_ge_u32 s93, 224
    s_cselect_b32 s44, 0x80000000, s5
    s_lshl_b32 s5, s28, 1
    s_add_u32 s5, s5, s7
    s_lshl_b32 s49, s5, 16
    s_lshl_b32 s5, s5, 13
    s_add_u32 s5, s5, s6
    s_lshl_b32 s6, s29, 10
    s_add_u32 s5, s5, s6
    s_add_u32 s45, s5, 0x1090000
    s_mul_i32 s46, s28, 229376
    s_lshl_b32 s5, s7, 17
    s_add_u32 s46, s46, s5
    s_lshl_b32 s47, s29, 3
    s_add_u32 s47, s47, s22
    s_lshl_b32 s47, s47, 5
    s_mul_i32 s5, s22, 57344
    s_mul_i32 s6, s28, 896
    s_add_u32 s5, s5, s6
    s_add_u32 s48, s5, 0x1010000
    s_lshl_b32 s5, s23, 1
    s_lshr_b32 s6, s22, 2
    s_add_u32 s5, s5, s6
    s_lshl_b32 s6, s21, 2
    s_add_u32 s5, s5, s6
    s_lshl_b32 s5, s5, 5
    s_lshl_b32 s6, s20, 1
    s_add_u32 s6, s6, s24
    s_add_u32 s5, s5, s6
    s_lshl_b32 s73, s5, 11
    s_add_u32 s73, s73, 0xc00000
    s_lshl_b32 s5, s5, 7
    s_add_u32 s95, s5, 0x1200000
    s_lshr_b32 s7, s22, 2
    s_and_b32 s6, s22, 3
    s_lshl_b32 s5, s7, 4
    s_add_u32 s5, s5, s6
    s_lshl_b32 s31, s28, 6
    s_add_u32 s31, s31, s5
    s_lshl_b32 s30, s31, 11
    s_add_u32 s30, s30, 0xc00000
    s_lshl_b32 s31, s31, 7
    s_add_u32 s31, s31, 0x1200000
    s_lshl_b32 s84, s7, 14
    s_lshl_b32 s5, s6, 11
    s_add_u32 s84, s84, s5
    s_lshl_b32 s81, s20, 7
    s_add_u32 s81, s81, 0x1009000
    v_and_b32 v37, 15, v0
    v_lshlrev_b32 v37, 3, v37
    v_mov_b32 v34, 0
    v_mov_b32 v35, 0
    v_and_b32 v4, 0x33, v0
    v_bfe_u32 v5, v0, 2, 1
    v_lshl_or_b32 v4, v5, 3, v4
    v_bfe_u32 v5, v0, 3, 1
    v_lshl_or_b32 v4, v5, 2, v4
    v_lshlrev_b32 v38, 4, v4
    v_mov_b32 v128, 0
    v_mov_b32 v129, 0
    v_mov_b32 v130, 0
    v_mov_b32 v131, 0
    v_mov_b32 v132, 0
    v_mov_b32 v133, 0
    v_mov_b32 v134, 0
    v_mov_b32 v135, 0
    v_mov_b32 v136, 0
    v_mov_b32 v137, 0
    v_mov_b32 v138, 0
    v_mov_b32 v139, 0
    v_mov_b32 v140, 0
    v_mov_b32 v141, 0
    v_mov_b32 v142, 0
    v_mov_b32 v143, 0
    v_mov_b32 v144, 0
    v_mov_b32 v145, 0
    v_mov_b32 v146, 0
    v_mov_b32 v147, 0
    v_mov_b32 v148, 0
    v_mov_b32 v149, 0
    v_mov_b32 v150, 0
    v_mov_b32 v151, 0
    v_mov_b32 v152, 0
    v_mov_b32 v153, 0
    v_mov_b32 v154, 0
    v_mov_b32 v155, 0
    v_mov_b32 v156, 0
    v_mov_b32 v157, 0
    v_mov_b32 v158, 0
    v_mov_b32 v159, 0
    v_mov_b32 v160, 0
    v_mov_b32 v161, 0
    v_mov_b32 v162, 0
    v_mov_b32 v163, 0
    v_mov_b32 v164, 0
    v_mov_b32 v165, 0
    v_mov_b32 v166, 0
    v_mov_b32 v167, 0
    v_mov_b32 v168, 0
    v_mov_b32 v169, 0
    v_mov_b32 v170, 0
    v_mov_b32 v171, 0
    v_mov_b32 v172, 0
    v_mov_b32 v173, 0
    v_mov_b32 v174, 0
    v_mov_b32 v175, 0
    v_mov_b32 v176, 0
    v_mov_b32 v177, 0
    v_mov_b32 v178, 0
    v_mov_b32 v179, 0
    v_mov_b32 v180, 0
    v_mov_b32 v181, 0
    v_mov_b32 v182, 0
    v_mov_b32 v183, 0
    v_mov_b32 v184, 0
    v_mov_b32 v185, 0
    v_mov_b32 v186, 0
    v_mov_b32 v187, 0
    v_mov_b32 v188, 0
    v_mov_b32 v189, 0
    v_mov_b32 v190, 0
    v_mov_b32 v191, 0
    v_mov_b32 v192, 0
    v_mov_b32 v193, 0
    v_mov_b32 v194, 0
    v_mov_b32 v195, 0
    v_mov_b32 v196, 0
    v_mov_b32 v197, 0
    v_mov_b32 v198, 0
    v_mov_b32 v199, 0
    v_mov_b32 v200, 0
    v_mov_b32 v201, 0
    v_mov_b32 v202, 0
    v_mov_b32 v203, 0
    v_mov_b32 v204, 0
    v_mov_b32 v205, 0
    v_mov_b32 v206, 0
    v_mov_b32 v207, 0
    v_mov_b32 v208, 0
    v_mov_b32 v209, 0
    v_mov_b32 v210, 0
    v_mov_b32 v211, 0
    v_mov_b32 v212, 0
    v_mov_b32 v213, 0
    v_mov_b32 v214, 0
    v_mov_b32 v215, 0
    v_mov_b32 v216, 0
    v_mov_b32 v217, 0
    v_mov_b32 v218, 0
    v_mov_b32 v219, 0
    v_mov_b32 v220, 0
    v_mov_b32 v221, 0
    v_mov_b32 v222, 0
    v_mov_b32 v223, 0
    s_mov_b32 s80, 0
    s_barrier
    ds_read_b128 v[40:43], v8 offset:0
    ds_read_b64_tr_b16 v[64:65], v12 offset:8192
    ds_read_b64_tr_b16 v[66:67], v12 offset:8704
    ds_read_b128 v[44:47], v8 offset:2048
    ds_read_b128 v[48:51], v8 offset:4096
    ds_read_b128 v[52:55], v8 offset:6144
    ds_read_b64_tr_b16 v[68:69], v13 offset:8192
    ds_read_b64_tr_b16 v[70:71], v13 offset:8704
    ds_read_b64_tr_b16 v[72:73], v12 offset:16384
    ds_read_b64_tr_b16 v[74:75], v12 offset:16896
    ds_read_b64_tr_b16 v[76:77], v13 offset:16384
    ds_read_b64_tr_b16 v[78:79], v13 offset:16896
    s_waitcnt lgkmcnt(4)
    ds_read_b64_tr_b16 v[56:57], v12 offset:0
    ds_read_b64_tr_b16 v[58:59], v12 offset:512
    ds_read_b64_tr_b16 v[60:61], v13 offset:0
    ds_read_b64_tr_b16 v[62:63], v13 offset:512
    s_waitcnt lgkmcnt(0)
.p2align 6
L_cl:
    v_mfma_f32_16x16x32_bf16 v[136:139], v[64:67], v[40:43], v[136:139]
    ds_read_b128 v[80:83], v9 offset:0
    v_mfma_f32_16x16x32_bf16 v[160:163], v[64:67], v[44:47], v[160:163]
    ds_read_b64_tr_b16 v[104:105], v12 offset:12288
    v_mfma_f32_16x16x32_bf16 v[184:187], v[64:67], v[48:51], v[184:187]
    ds_read_b64_tr_b16 v[106:107], v12 offset:12800
    v_mfma_f32_16x16x32_bf16 v[208:211], v[64:67], v[52:55], v[208:211]
    ds_read_b128 v[84:87], v9 offset:2048
    v_mfma_f32_16x16x32_bf16 v[140:143], v[68:71], v[40:43], v[140:143]
    ds_read_b128 v[88:91], v9 offset:4096
    v_mfma_f32_16x16x32_bf16 v[164:167], v[68:71], v[44:47], v[164:167]
    ds_read_b128 v[92:95], v9 offset:6144
    v_mfma_f32_16x16x32_bf16 v[188:191], v[68:71], v[48:51], v[188:191]
    ds_read_b64_tr_b16 v[108:109], v13 offset:12288
    v_mfma_f32_16x16x32_bf16 v[212:215], v[68:71], v[52:55], v[212:215]
    ds_read_b64_tr_b16 v[110:111], v13 offset:12800
    v_mfma_f32_16x16x32_bf16 v[144:147], v[40:43], v[72:75], v[144:147]
    ds_read_b64_tr_b16 v[112:113], v12 offset:20480
    v_mfma_f32_16x16x32_bf16 v[168:171], v[44:47], v[72:75], v[168:171]
    ds_read_b64_tr_b16 v[114:115], v12 offset:20992
    v_mfma_f32_16x16x32_bf16 v[192:195], v[48:51], v[72:75], v[192:195]
    ds_read_b64_tr_b16 v[116:117], v13 offset:20480
    v_mfma_f32_16x16x32_bf16 v[216:219], v[52:55], v[72:75], v[216:219]
    ds_read_b64_tr_b16 v[118:119], v13 offset:20992
    v_mfma_f32_16x16x32_bf16 v[148:151], v[40:43], v[76:79], v[148:151]
    ds_read_b64_tr_b16 v[96:97], v12 offset:4096
    v_mfma_f32_16x16x32_bf16 v[172:175], v[44:47], v[76:79], v[172:175]
    ds_read_b64_tr_b16 v[98:99], v12 offset:4608
    v_mfma_f32_16x16x32_bf16 v[196:199], v[48:51], v[76:79], v[196:199]
    ds_read_b64_tr_b16 v[100:101], v13 offset:4096
    v_mfma_f32_16x16x32_bf16 v[220:223], v[52:55], v[76:79], v[220:223]
    s_waitcnt lgkmcnt(14)
    ds_read_b64_tr_b16 v[102:103], v13 offset:4608
    v_mfma_f32_16x16x32_bf16 v[128:131], v[56:59], v[40:43], v[128:131]
    v_mfma_f32_16x16x32_bf16 v[152:155], v[56:59], v[44:47], v[152:155]
    v_mfma_f32_16x16x32_bf16 v[176:179], v[56:59], v[48:51], v[176:179]
    v_mfma_f32_16x16x32_bf16 v[200:203], v[56:59], v[52:55], v[200:203]
    v_mfma_f32_16x16x32_bf16 v[132:135], v[60:63], v[40:43], v[132:135]
    v_mfma_f32_16x16x32_bf16 v[156:159], v[60:63], v[44:47], v[156:159]
    v_mfma_f32_16x16x32_bf16 v[180:183], v[60:63], v[48:51], v[180:183]
    v_mfma_f32_16x16x32_bf16 v[204:207], v[60:63], v[52:55], v[204:207]
    s_waitcnt lgkmcnt(13)
    v_mfma_f32_16x16x32_bf16 v[136:139], v[104:107], v[80:83], v[136:139]
    s_waitcnt lgkmcnt(12)
    v_mfma_f32_16x16x32_bf16 v[160:163], v[104:107], v[84:87], v[160:163]
    s_waitcnt lgkmcnt(11)
    v_mfma_f32_16x16x32_bf16 v[184:187], v[104:107], v[88:91], v[184:187]
    s_waitcnt lgkmcnt(10)
    v_mfma_f32_16x16x32_bf16 v[208:211], v[104:107], v[92:95], v[208:211]
    s_waitcnt lgkmcnt(0)
    s_barrier
    v_mfma_f32_16x16x32_bf16 v[140:143], v[108:111], v[80:83], v[140:143]
    ds_read_b128 v[40:43], v8 offset:40960
    v_mfma_f32_16x16x32_bf16 v[164:167], v[108:111], v[84:87], v[164:167]
    ds_read_b64_tr_b16 v[64:65], v12 offset:49152
    v_mfma_f32_16x16x32_bf16 v[188:191], v[108:111], v[88:91], v[188:191]
    ds_read_b64_tr_b16 v[66:67], v12 offset:49664
    v_mfma_f32_16x16x32_bf16 v[212:215], v[108:111], v[92:95], v[212:215]
    ds_read_b128 v[44:47], v8 offset:43008
    v_mfma_f32_16x16x32_bf16 v[144:147], v[80:83], v[112:115], v[144:147]
    ds_read_b128 v[48:51], v8 offset:45056
    v_mfma_f32_16x16x32_bf16 v[168:171], v[84:87], v[112:115], v[168:171]
    ds_read_b128 v[52:55], v8 offset:47104
    v_mfma_f32_16x16x32_bf16 v[192:195], v[88:91], v[112:115], v[192:195]
    ds_read_b64_tr_b16 v[68:69], v13 offset:49152
    v_mfma_f32_16x16x32_bf16 v[216:219], v[92:95], v[112:115], v[216:219]
    ds_read_b64_tr_b16 v[70:71], v13 offset:49664
    v_mfma_f32_16x16x32_bf16 v[148:151], v[80:83], v[116:119], v[148:151]
    ds_read_b64_tr_b16 v[72:73], v12 offset:57344
    v_mfma_f32_16x16x32_bf16 v[172:175], v[84:87], v[116:119], v[172:175]
    ds_read_b64_tr_b16 v[74:75], v12 offset:57856
    v_mfma_f32_16x16x32_bf16 v[196:199], v[88:91], v[116:119], v[196:199]
    ds_read_b64_tr_b16 v[76:77], v13 offset:57344
    v_mfma_f32_16x16x32_bf16 v[220:223], v[92:95], v[116:119], v[220:223]
    ds_read_b64_tr_b16 v[78:79], v13 offset:57856
    v_mfma_f32_16x16x32_bf16 v[128:131], v[96:99], v[80:83], v[128:131]
    ds_read_b64_tr_b16 v[56:57], v12 offset:40960
    v_mfma_f32_16x16x32_bf16 v[152:155], v[96:99], v[84:87], v[152:155]
    ds_read_b64_tr_b16 v[58:59], v12 offset:41472
    v_mfma_f32_16x16x32_bf16 v[176:179], v[96:99], v[88:91], v[176:179]
    ds_read_b64_tr_b16 v[60:61], v13 offset:40960
    v_mfma_f32_16x16x32_bf16 v[200:203], v[96:99], v[92:95], v[200:203]
    s_waitcnt lgkmcnt(14)
    ds_read_b64_tr_b16 v[62:63], v13 offset:41472
    v_mfma_f32_16x16x32_bf16 v[132:135], v[100:103], v[80:83], v[132:135]
    v_mfma_f32_16x16x32_bf16 v[156:159], v[100:103], v[84:87], v[156:159]
    v_mfma_f32_16x16x32_bf16 v[180:183], v[100:103], v[88:91], v[180:183]
    v_mfma_f32_16x16x32_bf16 v[204:207], v[100:103], v[92:95], v[204:207]
    s_cmp_lg_u32 s80, 1
    s_cbranch_scc1 Lcj_15
    s_waitcnt vmcnt(0)
    v_readfirstlane_b32 s25, v36
    s_nop 3
    s_mul_i32 s25, s25, 0x9E3779B1
    s_add_u32 s25, s25, 0x7F4A7C15
Lcj_15:
    s_cmp_lg_u32 s80, 2
    s_cbranch_scc1 Lcj_16
    buffer_load_dwordx2 v[34:35], v37, s[16:19], s81 offen sc1
Lcj_16:
    s_waitcnt lgkmcnt(13)
    v_mfma_f32_16x16x32_bf16 v[136:139], v[64:67], v[40:43], v[136:139]
    ds_read_b128 v[80:83], v9 offset:40960
    s_waitcnt lgkmcnt(13)
    v_mfma_f32_16x16x32_bf16 v[160:163], v[64:67], v[44:47], v[160:163]
    ds_read_b64_tr_b16 v[104:105], v12 offset:53248
    s_waitcnt lgkmcnt(13)
    v_mfma_f32_16x16x32_bf16 v[184:187], v[64:67], v[48:51], v[184:187]
    ds_read_b64_tr_b16 v[106:107], v12 offset:53760
    s_waitcnt lgkmcnt(13)
    v_mfma_f32_16x16x32_bf16 v[208:211], v[64:67], v[52:55], v[208:211]
    ds_read_b128 v[84:87], v9 offset:43008
    s_waitcnt lgkmcnt(12)
    v_mfma_f32_16x16x32_bf16 v[140:143], v[68:71], v[40:43], v[140:143]
    ds_read_b128 v[88:91], v9 offset:45056
    v_mfma_f32_16x16x32_bf16 v[164:167], v[68:71], v[44:47], v[164:167]
    ds_read_b128 v[92:95], v9 offset:47104
    v_mfma_f32_16x16x32_bf16 v[188:191], v[68:71], v[48:51], v[188:191]
    ds_read_b64_tr_b16 v[108:109], v13 offset:53248
    v_mfma_f32_16x16x32_bf16 v[212:215], v[68:71], v[52:55], v[212:215]
    s_waitcnt lgkmcnt(14)
    ds_read_b64_tr_b16 v[110:111], v13 offset:53760
    s_waitcnt lgkmcnt(14)
    v_mfma_f32_16x16x32_bf16 v[144:147], v[40:43], v[72:75], v[144:147]
    ds_read_b64_tr_b16 v[112:113], v12 offset:61440
    v_mfma_f32_16x16x32_bf16 v[168:171], v[44:47], v[72:75], v[168:171]
    s_waitcnt lgkmcnt(14)
    ds_read_b64_tr_b16 v[114:115], v12 offset:61952
    v_mfma_f32_16x16x32_bf16 v[192:195], v[48:51], v[72:75], v[192:195]
    s_waitcnt lgkmcnt(14)
    ds_read_b64_tr_b16 v[116:117], v13 offset:61440
    v_mfma_f32_16x16x32_bf16 v[216:219], v[52:55], v[72:75], v[216:219]
    s_waitcnt lgkmcnt(14)
    ds_read_b64_tr_b16 v[118:119], v13 offset:61952
    v_mfma_f32_16x16x32_bf16 v[148:151], v[40:43], v[76:79], v[148:151]
    s_waitcnt lgkmcnt(14)
    ds_read_b64_tr_b16 v[96:97], v12 offset:45056
    v_mfma_f32_16x16x32_bf16 v[172:175], v[44:47], v[76:79], v[172:175]
    s_waitcnt lgkmcnt(14)
    ds_read_b64_tr_b16 v[98:99], v12 offset:45568
    v_mfma_f32_16x16x32_bf16 v[196:199], v[48:51], v[76:79], v[196:199]
    s_waitcnt lgkmcnt(14)
    ds_read_b64_tr_b16 v[100:101], v13 offset:45056
    v_mfma_f32_16x16x32_bf16 v[220:223], v[52:55], v[76:79], v[220:223]
    s_waitcnt lgkmcnt(14)
    ds_read_b64_tr_b16 v[102:103], v13 offset:45568
    v_mfma_f32_16x16x32_bf16 v[128:131], v[56:59], v[40:43], v[128:131]
    v_mfma_f32_16x16x32_bf16 v[152:155], v[56:59], v[44:47], v[152:155]
    v_mfma_f32_16x16x32_bf16 v[176:179], v[56:59], v[48:51], v[176:179]
    v_mfma_f32_16x16x32_bf16 v[200:203], v[56:59], v[52:55], v[200:203]
    v_mfma_f32_16x16x32_bf16 v[132:135], v[60:63], v[40:43], v[132:135]
    v_mfma_f32_16x16x32_bf16 v[156:159], v[60:63], v[44:47], v[156:159]
    v_mfma_f32_16x16x32_bf16 v[180:183], v[60:63], v[48:51], v[180:183]
    v_mfma_f32_16x16x32_bf16 v[204:207], v[60:63], v[52:55], v[204:207]
    s_waitcnt lgkmcnt(13)
    v_mfma_f32_16x16x32_bf16 v[136:139], v[104:107], v[80:83], v[136:139]
    s_waitcnt lgkmcnt(12)
    v_mfma_f32_16x16x32_bf16 v[160:163], v[104:107], v[84:87], v[160:163]
    s_waitcnt lgkmcnt(11)
    v_mfma_f32_16x16x32_bf16 v[184:187], v[104:107], v[88:91], v[184:187]
    s_waitcnt lgkmcnt(10)
    v_mfma_f32_16x16x32_bf16 v[208:211], v[104:107], v[92:95], v[208:211]
    s_waitcnt lgkmcnt(0)
    s_barrier
    v_mfma_f32_16x16x32_bf16 v[140:143], v[108:111], v[80:83], v[140:143]
    ds_read_b128 v[40:43], v10 offset:0
    v_mfma_f32_16x16x32_bf16 v[164:167], v[108:111], v[84:87], v[164:167]
    ds_read_b64_tr_b16 v[64:65], v14 offset:8192
    v_mfma_f32_16x16x32_bf16 v[188:191], v[108:111], v[88:91], v[188:191]
    ds_read_b64_tr_b16 v[66:67], v14 offset:8704
    v_mfma_f32_16x16x32_bf16 v[212:215], v[108:111], v[92:95], v[212:215]
    ds_read_b128 v[44:47], v10 offset:2048
    v_mfma_f32_16x16x32_bf16 v[144:147], v[80:83], v[112:115], v[144:147]
    ds_read_b128 v[48:51], v10 offset:4096
    v_mfma_f32_16x16x32_bf16 v[168:171], v[84:87], v[112:115], v[168:171]
    ds_read_b128 v[52:55], v10 offset:6144
    v_mfma_f32_16x16x32_bf16 v[192:195], v[88:91], v[112:115], v[192:195]
    ds_read_b64_tr_b16 v[68:69], v15 offset:8192
    v_mfma_f32_16x16x32_bf16 v[216:219], v[92:95], v[112:115], v[216:219]
    ds_read_b64_tr_b16 v[70:71], v15 offset:8704
    v_mfma_f32_16x16x32_bf16 v[148:151], v[80:83], v[116:119], v[148:151]
    ds_read_b64_tr_b16 v[72:73], v14 offset:16384
    v_mfma_f32_16x16x32_bf16 v[172:175], v[84:87], v[116:119], v[172:175]
    ds_read_b64_tr_b16 v[74:75], v14 offset:16896
    v_mfma_f32_16x16x32_bf16 v[196:199], v[88:91], v[116:119], v[196:199]
    ds_read_b64_tr_b16 v[76:77], v15 offset:16384
    v_mfma_f32_16x16x32_bf16 v[220:223], v[92:95], v[116:119], v[220:223]
    ds_read_b64_tr_b16 v[78:79], v15 offset:16896
    v_mfma_f32_16x16x32_bf16 v[128:131], v[96:99], v[80:83], v[128:131]
    ds_read_b64_tr_b16 v[56:57], v14 offset:0
    v_mfma_f32_16x16x32_bf16 v[152:155], v[96:99], v[84:87], v[152:155]
    ds_read_b64_tr_b16 v[58:59], v14 offset:512
    v_mfma_f32_16x16x32_bf16 v[176:179], v[96:99], v[88:91], v[176:179]
    ds_read_b64_tr_b16 v[60:61], v15 offset:0
    v_mfma_f32_16x16x32_bf16 v[200:203], v[96:99], v[92:95], v[200:203]
    s_waitcnt lgkmcnt(14)
    ds_read_b64_tr_b16 v[62:63], v15 offset:512
    v_mfma_f32_16x16x32_bf16 v[132:135], v[100:103], v[80:83], v[132:135]
    v_mfma_f32_16x16x32_bf16 v[156:159], v[100:103], v[84:87], v[156:159]
    v_mfma_f32_16x16x32_bf16 v[180:183], v[100:103], v[88:91], v[180:183]
    v_mfma_f32_16x16x32_bf16 v[204:207], v[100:103], v[92:95], v[204:207]
    s_waitcnt lgkmcnt(13)
    v_mfma_f32_16x16x32_bf16 v[136:139], v[64:67], v[40:43], v[136:139]
    ds_read_b128 v[80:83], v11 offset:0
    s_waitcnt lgkmcnt(13)
    v_mfma_f32_16x16x32_bf16 v[160:163], v[64:67], v[44:47], v[160:163]
    ds_read_b64_tr_b16 v[104:105], v14 offset:12288
    s_waitcnt lgkmcnt(13)
    v_mfma_f32_16x16x32_bf16 v[184:187], v[64:67], v[48:51], v[184:187]
    ds_read_b64_tr_b16 v[106:107], v14 offset:12800
    s_waitcnt lgkmcnt(13)
    v_mfma_f32_16x16x32_bf16 v[208:211], v[64:67], v[52:55], v[208:211]
    ds_read_b128 v[84:87], v11 offset:2048
    s_waitcnt lgkmcnt(12)
    v_mfma_f32_16x16x32_bf16 v[140:143], v[68:71], v[40:43], v[140:143]
    ds_read_b128 v[88:91], v11 offset:4096
    v_mfma_f32_16x16x32_bf16 v[164:167], v[68:71], v[44:47], v[164:167]
    ds_read_b128 v[92:95], v11 offset:6144
    v_mfma_f32_16x16x32_bf16 v[188:191], v[68:71], v[48:51], v[188:191]
    ds_read_b64_tr_b16 v[108:109], v15 offset:12288
    v_mfma_f32_16x16x32_bf16 v[212:215], v[68:71], v[52:55], v[212:215]
    s_waitcnt lgkmcnt(14)
    ds_read_b64_tr_b16 v[110:111], v15 offset:12800
    s_waitcnt lgkmcnt(14)
    v_mfma_f32_16x16x32_bf16 v[144:147], v[40:43], v[72:75], v[144:147]
    ds_read_b64_tr_b16 v[112:113], v14 offset:20480
    v_mfma_f32_16x16x32_bf16 v[168:171], v[44:47], v[72:75], v[168:171]
    s_waitcnt lgkmcnt(14)
    ds_read_b64_tr_b16 v[114:115], v14 offset:20992
    v_mfma_f32_16x16x32_bf16 v[192:195], v[48:51], v[72:75], v[192:195]
    s_waitcnt lgkmcnt(14)
    ds_read_b64_tr_b16 v[116:117], v15 offset:20480
    v_mfma_f32_16x16x32_bf16 v[216:219], v[52:55], v[72:75], v[216:219]
    s_waitcnt lgkmcnt(14)
    ds_read_b64_tr_b16 v[118:119], v15 offset:20992
    v_mfma_f32_16x16x32_bf16 v[148:151], v[40:43], v[76:79], v[148:151]
    s_waitcnt lgkmcnt(14)
    ds_read_b64_tr_b16 v[96:97], v14 offset:4096
    v_mfma_f32_16x16x32_bf16 v[172:175], v[44:47], v[76:79], v[172:175]
    s_waitcnt lgkmcnt(14)
    ds_read_b64_tr_b16 v[98:99], v14 offset:4608
    v_mfma_f32_16x16x32_bf16 v[196:199], v[48:51], v[76:79], v[196:199]
    s_waitcnt lgkmcnt(14)
    ds_read_b64_tr_b16 v[100:101], v15 offset:4096
    v_mfma_f32_16x16x32_bf16 v[220:223], v[52:55], v[76:79], v[220:223]
    s_waitcnt lgkmcnt(14)
    ds_read_b64_tr_b16 v[102:103], v15 offset:4608
    v_mfma_f32_16x16x32_bf16 v[128:131], v[56:59], v[40:43], v[128:131]
    v_mfma_f32_16x16x32_bf16 v[152:155], v[56:59], v[44:47], v[152:155]
    v_mfma_f32_16x16x32_bf16 v[176:179], v[56:59], v[48:51], v[176:179]
    v_mfma_f32_16x16x32_bf16 v[200:203], v[56:59], v[52:55], v[200:203]
    v_mfma_f32_16x16x32_bf16 v[132:135], v[60:63], v[40:43], v[132:135]
    v_mfma_f32_16x16x32_bf16 v[156:159], v[60:63], v[44:47], v[156:159]
    v_mfma_f32_16x16x32_bf16 v[180:183], v[60:63], v[48:51], v[180:183]
    v_mfma_f32_16x16x32_bf16 v[204:207], v[60:63], v[52:55], v[204:207]
    s_waitcnt lgkmcnt(13)
    v_mfma_f32_16x16x32_bf16 v[136:139], v[104:107], v[80:83], v[136:139]
    s_waitcnt lgkmcnt(12)
    v_mfma_f32_16x16x32_bf16 v[160:163], v[104:107], v[84:87], v[160:163]
    s_waitcnt lgkmcnt(11)
    v_mfma_f32_16x16x32_bf16 v[184:187], v[104:107], v[88:91], v[184:187]
    s_waitcnt lgkmcnt(10)
    v_mfma_f32_16x16x32_bf16 v[208:211], v[104:107], v[92:95], v[208:211]
    s_waitcnt lgkmcnt(0)
    s_barrier
    v_mfma_f32_16x16x32_bf16 v[140:143], v[108:111], v[80:83], v[140:143]
    ds_read_b128 v[40:43], v10 offset:40960
    v_mfma_f32_16x16x32_bf16 v[164:167], v[108:111], v[84:87], v[164:167]
    ds_read_b64_tr_b16 v[64:65], v14 offset:49152
    v_mfma_f32_16x16x32_bf16 v[188:191], v[108:111], v[88:91], v[188:191]
    ds_read_b64_tr_b16 v[66:67], v14 offset:49664
    v_mfma_f32_16x16x32_bf16 v[212:215], v[108:111], v[92:95], v[212:215]
    ds_read_b128 v[44:47], v10 offset:43008
    v_mfma_f32_16x16x32_bf16 v[144:147], v[80:83], v[112:115], v[144:147]
    ds_read_b128 v[48:51], v10 offset:45056
    v_mfma_f32_16x16x32_bf16 v[168:171], v[84:87], v[112:115], v[168:171]
    ds_read_b128 v[52:55], v10 offset:47104
    v_mfma_f32_16x16x32_bf16 v[192:195], v[88:91], v[112:115], v[192:195]
    ds_read_b64_tr_b16 v[68:69], v15 offset:49152
    v_mfma_f32_16x16x32_bf16 v[216:219], v[92:95], v[112:115], v[216:219]
    ds_read_b64_tr_b16 v[70:71], v15 offset:49664
    v_mfma_f32_16x16x32_bf16 v[148:151], v[80:83], v[116:119], v[148:151]
    ds_read_b64_tr_b16 v[72:73], v14 offset:57344
    v_mfma_f32_16x16x32_bf16 v[172:175], v[84:87], v[116:119], v[172:175]
    ds_read_b64_tr_b16 v[74:75], v14 offset:57856
    v_mfma_f32_16x16x32_bf16 v[196:199], v[88:91], v[116:119], v[196:199]
    ds_read_b64_tr_b16 v[76:77], v15 offset:57344
    v_mfma_f32_16x16x32_bf16 v[220:223], v[92:95], v[116:119], v[220:223]
    ds_read_b64_tr_b16 v[78:79], v15 offset:57856
    v_mfma_f32_16x16x32_bf16 v[128:131], v[96:99], v[80:83], v[128:131]
    ds_read_b64_tr_b16 v[56:57], v14 offset:40960
    v_mfma_f32_16x16x32_bf16 v[152:155], v[96:99], v[84:87], v[152:155]
    ds_read_b64_tr_b16 v[58:59], v14 offset:41472
    v_mfma_f32_16x16x32_bf16 v[176:179], v[96:99], v[88:91], v[176:179]
    ds_read_b64_tr_b16 v[60:61], v15 offset:40960
    v_mfma_f32_16x16x32_bf16 v[200:203], v[96:99], v[92:95], v[200:203]
    s_waitcnt lgkmcnt(14)
    ds_read_b64_tr_b16 v[62:63], v15 offset:41472
    v_mfma_f32_16x16x32_bf16 v[132:135], v[100:103], v[80:83], v[132:135]
    v_mfma_f32_16x16x32_bf16 v[156:159], v[100:103], v[84:87], v[156:159]
    v_mfma_f32_16x16x32_bf16 v[180:183], v[100:103], v[88:91], v[180:183]
    v_mfma_f32_16x16x32_bf16 v[204:207], v[100:103], v[92:95], v[204:207]
    s_waitcnt lgkmcnt(13)
    v_mfma_f32_16x16x32_bf16 v[136:139], v[64:67], v[40:43], v[136:139]
    ds_read_b128 v[80:83], v11 offset:40960
    s_waitcnt lgkmcnt(13)
    v_mfma_f32_16x16x32_bf16 v[160:163], v[64:67], v[44:47], v[160:163]
    ds_read_b64_tr_b16 v[104:105], v14 offset:53248
    s_waitcnt lgkmcnt(13)
    v_mfma_f32_16x16x32_bf16 v[184:187], v[64:67], v[48:51], v[184:187]
    ds_read_b64_tr_b16 v[106:107], v14 offset:53760
    s_waitcnt lgkmcnt(13)
    v_mfma_f32_16x16x32_bf16 v[208:211], v[64:67], v[52:55], v[208:211]
    ds_read_b128 v[84:87], v11 offset:43008
    s_waitcnt lgkmcnt(12)
    v_mfma_f32_16x16x32_bf16 v[140:143], v[68:71], v[40:43], v[140:143]
    ds_read_b128 v[88:91], v11 offset:45056
    v_mfma_f32_16x16x32_bf16 v[164:167], v[68:71], v[44:47], v[164:167]
    ds_read_b128 v[92:95], v11 offset:47104
    v_mfma_f32_16x16x32_bf16 v[188:191], v[68:71], v[48:51], v[188:191]
    ds_read_b64_tr_b16 v[108:109], v15 offset:53248
    v_mfma_f32_16x16x32_bf16 v[212:215], v[68:71], v[52:55], v[212:215]
    s_waitcnt lgkmcnt(14)
    ds_read_b64_tr_b16 v[110:111], v15 offset:53760
    s_waitcnt lgkmcnt(14)
    v_mfma_f32_16x16x32_bf16 v[144:147], v[40:43], v[72:75], v[144:147]
    ds_read_b64_tr_b16 v[112:113], v14 offset:61440
    v_mfma_f32_16x16x32_bf16 v[168:171], v[44:47], v[72:75], v[168:171]
    s_waitcnt lgkmcnt(14)
    ds_read_b64_tr_b16 v[114:115], v14 offset:61952
    v_mfma_f32_16x16x32_bf16 v[192:195], v[48:51], v[72:75], v[192:195]
    s_waitcnt lgkmcnt(14)
    ds_read_b64_tr_b16 v[116:117], v15 offset:61440
    v_mfma_f32_16x16x32_bf16 v[216:219], v[52:55], v[72:75], v[216:219]
    s_waitcnt lgkmcnt(14)
    ds_read_b64_tr_b16 v[118:119], v15 offset:61952
    v_mfma_f32_16x16x32_bf16 v[148:151], v[40:43], v[76:79], v[148:151]
    s_waitcnt lgkmcnt(14)
    ds_read_b64_tr_b16 v[96:97], v14 offset:45056
    v_mfma_f32_16x16x32_bf16 v[172:175], v[44:47], v[76:79], v[172:175]
    s_waitcnt lgkmcnt(14)
    ds_read_b64_tr_b16 v[98:99], v14 offset:45568
    v_mfma_f32_16x16x32_bf16 v[196:199], v[48:51], v[76:79], v[196:199]
    s_waitcnt lgkmcnt(14)
    ds_read_b64_tr_b16 v[100:101], v15 offset:45056
    v_mfma_f32_16x16x32_bf16 v[220:223], v[52:55], v[76:79], v[220:223]
    s_waitcnt lgkmcnt(14)
    ds_read_b64_tr_b16 v[102:103], v15 offset:45568
    v_mfma_f32_16x16x32_bf16 v[128:131], v[56:59], v[40:43], v[128:131]
    v_mfma_f32_16x16x32_bf16 v[152:155], v[56:59], v[44:47], v[152:155]
    v_mfma_f32_16x16x32_bf16 v[176:179], v[56:59], v[48:51], v[176:179]
    v_mfma_f32_16x16x32_bf16 v[200:203], v[56:59], v[52:55], v[200:203]
    v_mfma_f32_16x16x32_bf16 v[132:135], v[60:63], v[40:43], v[132:135]
    v_mfma_f32_16x16x32_bf16 v[156:159], v[60:63], v[44:47], v[156:159]
    v_mfma_f32_16x16x32_bf16 v[180:183], v[60:63], v[48:51], v[180:183]
    v_mfma_f32_16x16x32_bf16 v[204:207], v[60:63], v[52:55], v[204:207]
    s_waitcnt lgkmcnt(13)
    v_mfma_f32_16x16x32_bf16 v[136:139], v[104:107], v[80:83], v[136:139]
    s_waitcnt lgkmcnt(12)
    v_mfma_f32_16x16x32_bf16 v[160:163], v[104:107], v[84:87], v[160:163]
    s_waitcnt lgkmcnt(11)
    v_mfma_f32_16x16x32_bf16 v[184:187], v[104:107], v[88:91], v[184:187]
    s_waitcnt lgkmcnt(10)
    v_mfma_f32_16x16x32_bf16 v[208:211], v[104:107], v[92:95], v[208:211]
    s_waitcnt lgkmcnt(0)
    s_cmp_eq_u32 s80, 3
    s_cbranch_scc1 L_cx
    s_barrier
    v_mfma_f32_16x16x32_bf16 v[140:143], v[108:111], v[80:83], v[140:143]
    ds_read_b128 v[40:43], v8 offset:0
    v_mfma_f32_16x16x32_bf16 v[164:167], v[108:111], v[84:87], v[164:167]
    ds_read_b64_tr_b16 v[64:65], v12 offset:8192
    v_mfma_f32_16x16x32_bf16 v[188:191], v[108:111], v[88:91], v[188:191]
    ds_read_b64_tr_b16 v[66:67], v12 offset:8704
    v_mfma_f32_16x16x32_bf16 v[212:215], v[108:111], v[92:95], v[212:215]
    ds_read_b128 v[44:47], v8 offset:2048
    v_mfma_f32_16x16x32_bf16 v[144:147], v[80:83], v[112:115], v[144:147]
    ds_read_b128 v[48:51], v8 offset:4096
    v_mfma_f32_16x16x32_bf16 v[168:171], v[84:87], v[112:115], v[168:171]
    ds_read_b128 v[52:55], v8 offset:6144
    v_mfma_f32_16x16x32_bf16 v[192:195], v[88:91], v[112:115], v[192:195]
    ds_read_b64_tr_b16 v[68:69], v13 offset:8192
    v_mfma_f32_16x16x32_bf16 v[216:219], v[92:95], v[112:115], v[216:219]
    ds_read_b64_tr_b16 v[70:71], v13 offset:8704
    v_mfma_f32_16x16x32_bf16 v[148:151], v[80:83], v[116:119], v[148:151]
    ds_read_b64_tr_b16 v[72:73], v12 offset:16384
    v_mfma_f32_16x16x32_bf16 v[172:175], v[84:87], v[116:119], v[172:175]
    ds_read_b64_tr_b16 v[74:75], v12 offset:16896
    v_mfma_f32_16x16x32_bf16 v[196:199], v[88:91], v[116:119], v[196:199]
    ds_read_b64_tr_b16 v[76:77], v13 offset:16384
    v_mfma_f32_16x16x32_bf16 v[220:223], v[92:95], v[116:119], v[220:223]
    ds_read_b64_tr_b16 v[78:79], v13 offset:16896
    v_mfma_f32_16x16x32_bf16 v[128:131], v[96:99], v[80:83], v[128:131]
    ds_read_b64_tr_b16 v[56:57], v12 offset:0
    v_mfma_f32_16x16x32_bf16 v[152:155], v[96:99], v[84:87], v[152:155]
    ds_read_b64_tr_b16 v[58:59], v12 offset:512
    v_mfma_f32_16x16x32_bf16 v[176:179], v[96:99], v[88:91], v[176:179]
    ds_read_b64_tr_b16 v[60:61], v13 offset:0
    v_mfma_f32_16x16x32_bf16 v[200:203], v[96:99], v[92:95], v[200:203]
    s_waitcnt lgkmcnt(14)
    ds_read_b64_tr_b16 v[62:63], v13 offset:512
    v_mfma_f32_16x16x32_bf16 v[132:135], v[100:103], v[80:83], v[132:135]
    v_mfma_f32_16x16x32_bf16 v[156:159], v[100:103], v[84:87], v[156:159]
    v_mfma_f32_16x16x32_bf16 v[180:183], v[100:103], v[88:91], v[180:183]
    v_mfma_f32_16x16x32_bf16 v[204:207], v[100:103], v[92:95], v[204:207]
    s_add_u32 s80, s80, 1
    s_waitcnt lgkmcnt(0)
    s_branch L_cl
L_cx:
    v_mfma_f32_16x16x32_bf16 v[140:143], v[108:111], v[80:83], v[140:143]
    v_mfma_f32_16x16x32_bf16 v[164:167], v[108:111], v[84:87], v[164:167]
    v_mfma_f32_16x16x32_bf16 v[188:191], v[108:111], v[88:91], v[188:191]
    v_mfma_f32_16x16x32_bf16 v[212:215], v[108:111], v[92:95], v[212:215]
    v_mfma_f32_16x16x32_bf16 v[144:147], v[80:83], v[112:115], v[144:147]
    v_mfma_f32_16x16x32_bf16 v[168:171], v[84:87], v[112:115], v[168:171]
    v_mfma_f32_16x16x32_bf16 v[192:195], v[88:91], v[112:115], v[192:195]
    v_mfma_f32_16x16x32_bf16 v[216:219], v[92:95], v[112:115], v[216:219]
    v_mfma_f32_16x16x32_bf16 v[148:151], v[80:83], v[116:119], v[148:151]
    v_mfma_f32_16x16x32_bf16 v[172:175], v[84:87], v[116:119], v[172:175]
    v_mfma_f32_16x16x32_bf16 v[196:199], v[88:91], v[116:119], v[196:199]
    v_mfma_f32_16x16x32_bf16 v[220:223], v[92:95], v[116:119], v[220:223]
    v_mfma_f32_16x16x32_bf16 v[128:131], v[96:99], v[80:83], v[128:131]
    v_mfma_f32_16x16x32_bf16 v[152:155], v[96:99], v[84:87], v[152:155]
    v_mfma_f32_16x16x32_bf16 v[176:179], v[96:99], v[88:91], v[176:179]
    v_mfma_f32_16x16x32_bf16 v[200:203], v[96:99], v[92:95], v[200:203]
    v_mfma_f32_16x16x32_bf16 v[132:135], v[100:103], v[80:83], v[132:135]
    v_mfma_f32_16x16x32_bf16 v[156:159], v[100:103], v[84:87], v[156:159]
    v_mfma_f32_16x16x32_bf16 v[180:183], v[100:103], v[88:91], v[180:183]
    v_mfma_f32_16x16x32_bf16 v[204:207], v[100:103], v[92:95], v[204:207]
    s_waitcnt vmcnt(0)
    v_cmp_ne_u32 vcc, s72, v34
    v_cmp_ne_u32 s[96:97], s25, v35
    s_nop 1
    s_or_b64 s[96:97], vcc, s[96:97]
    s_lshl_b32 s6, s21, 15
    s_add_u32 s6, s6, s34
    s_lshl_b32 s5, s24, 14
    s_lshl_b32 s7, s23, 13
    s_add_u32 s5, s5, s7
    s_add_u32 s6, s6, s5
    s_add_u32 s7, s6, 4096
    s_add_u32 s5, s5, 65536
    v_add_u32 v4, s5, v1
    v_add_u32 v5, s5, v38
    s_mov_b32 s98, 0x3e8293ee
    s_cmp_lg_u64 s[96:97], 0
    s_cbranch_scc1 Lool_17
Lret_18:
    v_cvt_pk_bf16_f32 v48, v136, v137
    v_cvt_pk_bf16_f32 v49, v138, v139
    v_cvt_pk_bf16_f32 v50, v160, v161
    v_cvt_pk_bf16_f32 v51, v162, v163
    v_cvt_pk_bf16_f32 v52, v140, v141
    v_cvt_pk_bf16_f32 v53, v142, v143
    v_cvt_pk_bf16_f32 v54, v164, v165
    v_cvt_pk_bf16_f32 v55, v166, v167
    v_permlane16_swap_b32 v48, v50
    v_permlane16_swap_b32 v49, v51
    buffer_store_dwordx4 v[48:51], v38, s[16:19], s6 offen offset:0
    v_cvt_pk_bf16_f32 v56, v144, v145
    v_cvt_pk_bf16_f32 v57, v146, v147
    v_cvt_pk_bf16_f32 v58, v148, v149
    v_cvt_pk_bf16_f32 v59, v150, v151
    v_permlane16_swap_b32 v52, v54
    v_permlane16_swap_b32 v53, v55
    buffer_store_dwordx4 v[52:55], v38, s[16:19], s6 offen offset:1024
    v_cvt_pk_bf16_f32 v60, v168, v169
    v_cvt_pk_bf16_f32 v61, v170, v171
    v_cvt_pk_bf16_f32 v62, v172, v173
    v_cvt_pk_bf16_f32 v63, v174, v175
    v_permlane16_swap_b32 v56, v58
    v_permlane16_swap_b32 v57, v59
    buffer_store_dwordx4 v[56:59], v1, s[16:19], s6 offen offset:2048
    v_cvt_pk_bf16_f32 v64, v184, v185
    v_cvt_pk_bf16_f32 v65, v186, v187
    v_cvt_pk_bf16_f32 v66, v208, v209
    v_cvt_pk_bf16_f32 v67, v210, v211
    v_permlane16_swap_b32 v60, v62
    v_permlane16_swap_b32 v61, v63
    buffer_store_dwordx4 v[60:63], v1, s[16:19], s6 offen offset:3072
    v_cvt_pk_bf16_f32 v68, v188, v189
    v_cvt_pk_bf16_f32 v69, v190, v191
    v_cvt_pk_bf16_f32 v70, v212, v213
    v_cvt_pk_bf16_f32 v71, v214, v215
    v_permlane16_swap_b32 v64, v66
    v_permlane16_swap_b32 v65, v67
    buffer_store_dwordx4 v[64:67], v38, s[16:19], s7 offen offset:0
    v_cvt_pk_bf16_f32 v72, v192, v193
    v_cvt_pk_bf16_f32 v73, v194, v195
    v_cvt_pk_bf16_f32 v74, v196, v197
    v_cvt_pk_bf16_f32 v75, v198, v199
    v_permlane16_swap_b32 v68, v70
    v_permlane16_swap_b32 v69, v71
    buffer_store_dwordx4 v[68:71], v38, s[16:19], s7 offen offset:1024
    v_cvt_pk_bf16_f32 v76, v216, v217
    v_cvt_pk_bf16_f32 v77, v218, v219
    v_cvt_pk_bf16_f32 v78, v220, v221
    v_cvt_pk_bf16_f32 v79, v222, v223
    v_permlane16_swap_b32 v72, v74
    v_permlane16_swap_b32 v73, v75
    buffer_store_dwordx4 v[72:75], v1, s[16:19], s7 offen offset:2048
    s_nop 1
    v_permlane16_swap_b32 v76, v78
    v_permlane16_swap_b32 v77, v79
    buffer_store_dwordx4 v[76:79], v1, s[16:19], s7 offen offset:3072
L_kvj:
    ds_write_b128 v5, v[48:51] offset:0
    ds_write_b128 v5, v[52:55] offset:1024
    ds_write_b128 v4, v[56:59] offset:2048
    ds_write_b128 v4, v[60:63] offset:3072
    ds_write_b128 v5, v[64:67] offset:4096
    ds_write_b128 v5, v[68:71] offset:5120
    ds_write_b128 v4, v[72:75] offset:6144
    ds_write_b128 v4, v[76:79] offset:7168
    s_lshl_b32 s5, s22, 11
    s_add_u32 s5, s5, 32768
    v_add_u32 v5, s5, v1
    v_mul_f32 v176, s98, v176
    v_mul_f32 v177, s98, v177
    v_mul_f32 v178, s98, v178
    v_mul_f32 v179, s98, v179
    v_cvt_pk_bf16_f32 v80, v176, v177
    v_cvt_pk_bf16_f32 v81, v178, v179
    v_mul_f32 v200, s98, v200
    v_mul_f32 v201, s98, v201
    v_mul_f32 v202, s98, v202
    v_mul_f32 v203, s98, v203
    v_cvt_pk_bf16_f32 v82, v200, v201
    v_cvt_pk_bf16_f32 v83, v202, v203
    v_mul_f32 v180, s98, v180
    v_mul_f32 v181, s98, v181
    v_mul_f32 v182, s98, v182
    v_mul_f32 v183, s98, v183
    v_cvt_pk_bf16_f32 v84, v180, v181
    v_cvt_pk_bf16_f32 v85, v182, v183
    v_mul_f32 v204, s98, v204
    v_mul_f32 v205, s98, v205
    v_mul_f32 v206, s98, v206
    v_mul_f32 v207, s98, v207
    v_cvt_pk_bf16_f32 v86, v204, v205
    v_cvt_pk_bf16_f32 v87, v206, v207
    v_permlane16_swap_b32 v80, v82
    v_permlane16_swap_b32 v81, v83
    v_mul_f32 v128, s98, v128
    v_mul_f32 v129, s98, v129
    v_mul_f32 v130, s98, v130
    v_mul_f32 v131, s98, v131
    v_cvt_pk_bf16_f32 v8, v128, v129
    v_cvt_pk_bf16_f32 v9, v130, v131
    v_mul_f32 v152, s98, v152
    v_mul_f32 v153, s98, v153
    v_mul_f32 v154, s98, v154
    v_mul_f32 v155, s98, v155
    v_cvt_pk_bf16_f32 v10, v152, v153
    v_cvt_pk_bf16_f32 v11, v154, v155
    v_permlane16_swap_b32 v84, v86
    v_permlane16_swap_b32 v85, v87
    ds_write_b128 v5, v[80:83]
    ds_write_b128 v5, v[84:87] offset:1024
    v_mul_f32 v132, s98, v132
    v_mul_f32 v133, s98, v133
    v_mul_f32 v134, s98, v134
    v_mul_f32 v135, s98, v135
    v_cvt_pk_bf16_f32 v12, v132, v133
    v_cvt_pk_bf16_f32 v13, v134, v135
    v_mul_f32 v156, s98, v156
    v_mul_f32 v157, s98, v157
    v_mul_f32 v158, s98, v158
    v_mul_f32 v159, s98, v159
    v_cvt_pk_bf16_f32 v14, v156, v157
    v_cvt_pk_bf16_f32 v15, v158, v159
    v_permlane16_swap_b32 v8, v10
    v_permlane16_swap_b32 v9, v11
    s_nop 0
    v_permlane16_swap_b32 v12, v14
    v_permlane16_swap_b32 v13, v15
    s_lshl_b32 s5, s20, 4
    s_add_u32 s5, s5, s21
    s_lshl_b32 s5, s5, 2
    s_add_u32 s5, s5, s22
    s_lshl_b32 s5, s5, 2
    s_add_u32 s5, s5, 0x1008000
    v_mov_b32 v4, 0
    v_mov_b32 v5, s25
    s_waitcnt vmcnt(0)
    s_mov_b64 exec, 1
    s_cmp_lg_u64 s[96:97], 0
    s_cbranch_scc1 Lool_19
Lret_20:
    buffer_store_dword v5, v4, s[16:19], s5 offen
L_flj:
    s_mov_b64 exec, -1
    s_waitcnt lgkmcnt(0)
    s_barrier
L_p2:
    ds_read_b128 v[104:107], v6 offset:0
    ds_read_b128 v[108:111], v6 offset:1024
    ds_read_b128 v[112:115], v6 offset:2048
    v_mov_b32 v4, 98560
    ds_read_b32 v98, v4 offset:8
    s_waitcnt lgkmcnt(0)
    v_mfma_f32_32x32x16_bf16 v[48:63], v[104:107], v[8:11], 0
    v_mfma_f32_32x32x16_bf16 v[48:63], v[108:111], v[12:15], v[48:63]
    v_readfirstlane_b32 s25, v98
    s_nop 10
    v_max3_f32 v4, v48, v49, v50
    v_max3_f32 v4, v4, v51, v52
    v_max3_f32 v4, v4, v53, v54
    v_max3_f32 v4, v4, v55, v56
    v_max3_f32 v4, v4, v57, v58
    v_max3_f32 v4, v4, v59, v60
    v_max3_f32 v4, v4, v61, v62
    v_max_f32 v4, v4, v63
    v_mov_b32 v5, v4
    s_nop 1
    v_permlane32_swap_b32 v4, v5
    v_max_f32 v4, v4, v5
    v_sub_f32 v32, 0, v4
    v_sub_f32 v33, 0, v4
    v_sub_f32 v34, 0, v4
    v_sub_f32 v35, 0, v4
    v_sub_f32 v36, 0, v4
    v_sub_f32 v37, 0, v4
    v_sub_f32 v38, 0, v4
    v_sub_f32 v39, 0, v4
    v_sub_f32 v40, 0, v4
    v_sub_f32 v41, 0, v4
    v_sub_f32 v42, 0, v4
    v_sub_f32 v43, 0, v4
    v_sub_f32 v44, 0, v4
    v_sub_f32 v45, 0, v4
    v_sub_f32 v46, 0, v4
    v_sub_f32 v47, 0, v4
    s_nop 1
    v_mfma_f32_32x32x16_bf16 v[48:63], v[104:107], v[8:11], v[32:47]
    v_mfma_f32_32x32x16_bf16 v[48:63], v[108:111], v[12:15], v[48:63]
    ds_read_b128 v[104:107], v6 offset:4096
    ds_read_b128 v[108:111], v6 offset:5120
    s_nop 9
    s_lshl_b32 s83, s20, 8
    s_add_u32 s83, s83, 0x1008000
    v_lshlrev_b32 v31, 2, v0
    s_mov_b32 s76, 0
    buffer_load_dword v30, v31, s[16:19], s83 offen sc1
    v_exp_f32 v48, v48
    v_exp_f32 v49, v49
    v_exp_f32 v50, v50
    s_waitcnt lgkmcnt(0)
    v_exp_f32 v51, v51
    ds_read_b128 v[116:119], v6 offset:3072
    v_cvt_pk_bf16_f32 v96, v48, v49
    v_exp_f32 v52, v52
    v_exp_f32 v53, v53
    v_cvt_pk_bf16_f32 v97, v50, v51
    v_mfma_f32_32x32x16_bf16 v[64:79], v[104:107], v[8:11], v[32:47]
    v_exp_f32 v54, v54
    v_exp_f32 v55, v55
    v_cvt_pk_bf16_f32 v98, v52, v53
    v_exp_f32 v56, v56
    v_mfma_f32_32x32x16_bf16 v[64:79], v[108:111], v[12:15], v[64:79]
    ds_read_b128 v[104:107], v6 offset:8192
    ds_read_b128 v[108:111], v6 offset:9216
    v_cvt_pk_bf16_f32 v99, v54, v55
    v_exp_f32 v57, v57
    v_exp_f32 v58, v58
    v_exp_f32 v59, v59
    v_mfma_f32_32x32x16_bf16 v[80:95], v[112:115], v[96:99], 0
    ds_read_b128 v[112:115], v6 offset:6144
    v_cvt_pk_bf16_f32 v100, v56, v57
    v_exp_f32 v60, v60
    v_exp_f32 v61, v61
    v_cvt_pk_bf16_f32 v101, v58, v59
    v_exp_f32 v62, v62
    v_exp_f32 v63, v63
    v_cvt_pk_bf16_f32 v102, v60, v61
    s_cmp_lt_u32 s76, 2
    s_cbranch_scc1 Lool_21
Lret_22:
    v_exp_f32 v64, v64
    v_cvt_pk_bf16_f32 v103, v62, v63
    v_exp_f32 v65, v65
    v_exp_f32 v66, v66
    s_waitcnt lgkmcnt(0)
    v_smfmac_f32_16x16x64_bf16 v[20:23], v[16:19], v[96:103], v127
    v_exp_f32 v67, v67
    v_mfma_f32_32x32x16_bf16 v[80:95], v[116:119], v[100:103], v[80:95]
    ds_read_b128 v[116:119], v6 offset:7168
    v_cvt_pk_bf16_f32 v96, v64, v65
    v_exp_f32 v68, v68
    v_exp_f32 v69, v69
    v_cvt_pk_bf16_f32 v97, v66, v67
    v_mfma_f32_32x32x16_bf16 v[48:63], v[104:107], v[8:11], v[32:47]
    v_exp_f32 v70, v70
    v_exp_f32 v71, v71
    v_cvt_pk_bf16_f32 v98, v68, v69
    v_exp_f32 v72, v72
    v_mfma_f32_32x32x16_bf16 v[48:63], v[108:111], v[12:15], v[48:63]
    ds_read_b128 v[104:107], v6 offset:12288
    ds_read_b128 v[108:111], v6 offset:13312
    v_cvt_pk_bf16_f32 v99, v70, v71
    v_exp_f32 v73, v73
    v_exp_f32 v74, v74
    v_exp_f32 v75, v75
    v_mfma_f32_32x32x16_bf16 v[80:95], v[112:115], v[96:99], v[80:95]
    ds_read_b128 v[112:115], v6 offset:10240
    v_cvt_pk_bf16_f32 v100, v72, v73
    v_exp_f32 v76, v76
    v_exp_f32 v77, v77
    v_cvt_pk_bf16_f32 v101, v74, v75
    v_exp_f32 v78, v78
    v_exp_f32 v79, v79
    v_cvt_pk_bf16_f32 v102, v76, v77
    s_cmp_lt_u32 s76, 2
    s_cbranch_scc1 Lool_26
Lret_27:
    v_exp_f32 v48, v48
    v_cvt_pk_bf16_f32 v103, v78, v79
    v_exp_f32 v49, v49
    v_exp_f32 v50, v50
    s_waitcnt lgkmcnt(0)
    v_smfmac_f32_16x16x64_bf16 v[20:23], v[16:19], v[96:103], v127
    v_exp_f32 v51, v51
    v_mfma_f32_32x32x16_bf16 v[80:95], v[116:119], v[100:103], v[80:95]
    ds_read_b128 v[116:119], v6 offset:11264
    v_cvt_pk_bf16_f32 v96, v48, v49
    v_exp_f32 v52, v52
    v_exp_f32 v53, v53
    v_cvt_pk_bf16_f32 v97, v50, v51
    v_mfma_f32_32x32x16_bf16 v[64:79], v[104:107], v[8:11], v[32:47]
    v_exp_f32 v54, v54
    v_exp_f32 v55, v55
    v_cvt_pk_bf16_f32 v98, v52, v53
    v_exp_f32 v56, v56
    v_mfma_f32_32x32x16_bf16 v[64:79], v[108:111], v[12:15], v[64:79]
    v_cvt_pk_bf16_f32 v99, v54, v55
    v_exp_f32 v57, v57
    v_exp_f32 v58, v58
    v_exp_f32 v59, v59
    v_mfma_f32_32x32x16_bf16 v[80:95], v[112:115], v[96:99], v[80:95]
    ds_read_b128 v[112:115], v6 offset:14336
    v_cvt_pk_bf16_f32 v100, v56, v57
    v_exp_f32 v60, v60
    v_exp_f32 v61, v61
    v_cvt_pk_bf16_f32 v101, v58, v59
    v_exp_f32 v62, v62
    v_exp_f32 v63, v63
    v_cvt_pk_bf16_f32 v102, v60, v61
    s_cmp_lt_u32 s76, 2
    s_cbranch_scc1 Lool_31
Lret_32:
    v_exp_f32 v64, v64
    v_cvt_pk_bf16_f32 v103, v62, v63
    v_exp_f32 v65, v65
    v_exp_f32 v66, v66
    s_waitcnt lgkmcnt(0)
    v_smfmac_f32_16x16x64_bf16 v[20:23], v[16:19], v[96:103], v127
    v_exp_f32 v67, v67
    v_mfma_f32_32x32x16_bf16 v[80:95], v[116:119], v[100:103], v[80:95]
    ds_read_b128 v[116:119], v6 offset:15360
    v_cvt_pk_bf16_f32 v96, v64, v65
    v_exp_f32 v68, v68
    v_exp_f32 v69, v69
    v_cvt_pk_bf16_f32 v97, v66, v67
    v_exp_f32 v70, v70
    v_exp_f32 v71, v71
    v_cvt_pk_bf16_f32 v98, v68, v69
    v_exp_f32 v72, v72
    v_cvt_pk_bf16_f32 v99, v70, v71
    v_exp_f32 v73, v73
    v_exp_f32 v74, v74
    v_exp_f32 v75, v75
    v_mfma_f32_32x32x16_bf16 v[80:95], v[112:115], v[96:99], v[80:95]
    v_cvt_pk_bf16_f32 v100, v72, v73
    v_exp_f32 v76, v76
    v_exp_f32 v77, v77
    v_cvt_pk_bf16_f32 v101, v74, v75
    v_exp_f32 v78, v78
    v_exp_f32 v79, v79
    v_cvt_pk_bf16_f32 v102, v76, v77
    s_nop 0
    v_cvt_pk_bf16_f32 v103, v78, v79
    s_nop 1
    v_smfmac_f32_16x16x64_bf16 v[20:23], v[16:19], v[96:103], v127
    s_waitcnt lgkmcnt(0)
    v_mfma_f32_32x32x16_bf16 v[80:95], v[116:119], v[100:103], v[80:95]
    s_cmp_lt_u32 s76, 2
    s_cbranch_scc1 Lool_36
Lret_37:
    s_waitcnt vmcnt(4)
    s_barrier
    ds_read_b128 v[104:107], v7 offset:0
    ds_read_b128 v[108:111], v7 offset:1024
    ds_read_b128 v[112:115], v7 offset:2048
    s_add_u32 s32, s21, 3
    s_and_b32 s32, s32, 15
    s_lshl_b32 s32, s32, 15
    s_add_u32 s32, s32, s34
    s_and_b32 s50, s32, 0x7ffff
    s_waitcnt lgkmcnt(2)
    v_mfma_f32_32x32x16_bf16 v[48:63], v[104:107], v[8:11], v[32:47]
    s_waitcnt lgkmcnt(1)
    v_mfma_f32_32x32x16_bf16 v[48:63], v[108:111], v[12:15], v[48:63]
    ds_read_b128 v[104:107], v7 offset:4096
    ds_read_b128 v[108:111], v7 offset:5120
    s_nop 9
    s_waitcnt vmcnt(0)
    ds_add_u32 v26, v27
    s_setprio 1
    v_exp_f32 v48, v48
    v_exp_f32 v49, v49
    v_exp_f32 v50, v50
    s_waitcnt lgkmcnt(0)
    v_exp_f32 v51, v51
    ds_read_b128 v[116:119], v7 offset:3072
    v_cvt_pk_bf16_f32 v96, v48, v49
    v_exp_f32 v52, v52
    v_exp_f32 v53, v53
    v_cvt_pk_bf16_f32 v97, v50, v51
    s_add_u32 m0, s35, 32768
    s_nop 0
    buffer_load_dwordx4 v2, s[16:19], s32 offen offset:0 sc1 lds
    v_mfma_f32_32x32x16_bf16 v[64:79], v[104:107], v[8:11], v[32:47]
    v_exp_f32 v54, v54
    v_exp_f32 v55, v55
    v_cvt_pk_bf16_f32 v98, v52, v53
    v_exp_f32 v56, v56
    v_mfma_f32_32x32x16_bf16 v[64:79], v[108:111], v[12:15], v[64:79]
    ds_read_b128 v[104:107], v7 offset:8192
    ds_read_b128 v[108:111], v7 offset:9216
    v_cvt_pk_bf16_f32 v99, v54, v55
    v_exp_f32 v57, v57
    v_exp_f32 v58, v58
    v_exp_f32 v59, v59
    v_mfma_f32_32x32x16_bf16 v[80:95], v[112:115], v[96:99], v[80:95]
    ds_read_b128 v[112:115], v7 offset:6144
    v_cvt_pk_bf16_f32 v100, v56, v57
    v_exp_f32 v60, v60
    v_exp_f32 v61, v61
    v_cvt_pk_bf16_f32 v101, v58, v59
    buffer_load_dwordx4 v2, s[16:19], s32 offen offset:1024 sc1 lds
    v_exp_f32 v62, v62
    v_exp_f32 v63, v63
    v_cvt_pk_bf16_f32 v102, v60, v61
    buffer_load_dwordx4 v2, s[16:19], s32 offen offset:2048 sc1 lds
    s_lshl_b32 s5, s2, 3
    s_add_u32 s5, s5, s22
    s_cmp_eq_u32 s5, 7
    s_cbranch_scc1 Lool_43
Lret_44:
    s_setprio 0
    v_exp_f32 v64, v64
    v_cvt_pk_bf16_f32 v103, v62, v63
    v_exp_f32 v65, v65
    v_exp_f32 v66, v66
    s_waitcnt lgkmcnt(0)
    buffer_load_dwordx4 v2, s[16:19], s32 offen offset:3072 sc1 lds
    v_smfmac_f32_16x16x64_bf16 v[20:23], v[16:19], v[96:103], v127
    v_exp_f32 v67, v67
    v_mfma_f32_32x32x16_bf16 v[80:95], v[116:119], v[100:103], v[80:95]
    ds_read_b128 v[116:119], v7 offset:7168
    v_cvt_pk_bf16_f32 v96, v64, v65
    v_exp_f32 v68, v68
    v_exp_f32 v69, v69
    v_cvt_pk_bf16_f32 v97, v66, v67
    s_add_u32 m0, s77, 106496
    s_lshl_b32 s33, s28, 15
    buffer_load_dwordx4 v24, s[36:39], s33 offen nt lds
    v_mfma_f32_32x32x16_bf16 v[48:63], v[104:107], v[8:11], v[32:47]
    v_exp_f32 v70, v70
    v_exp_f32 v71, v71
    v_cvt_pk_bf16_f32 v98, v68, v69
    v_exp_f32 v72, v72
    v_mfma_f32_32x32x16_bf16 v[48:63], v[108:111], v[12:15], v[48:63]
    ds_read_b128 v[104:107], v7 offset:12288
    ds_read_b128 v[108:111], v7 offset:13312
    v_cvt_pk_bf16_f32 v99, v70, v71
    v_exp_f32 v73, v73
    v_exp_f32 v74, v74
    v_exp_f32 v75, v75
    v_mfma_f32_32x32x16_bf16 v[80:95], v[112:115], v[96:99], v[80:95]
    ds_read_b128 v[112:115], v7 offset:10240
    v_cvt_pk_bf16_f32 v100, v72, v73
    v_exp_f32 v76, v76
    v_exp_f32 v77, v77
    v_cvt_pk_bf16_f32 v101, v74, v75
    v_exp_f32 v78, v78
    v_exp_f32 v79, v79
    v_cvt_pk_bf16_f32 v102, v76, v77
    s_add_u32 s50, s50, 32768
    s_and_b32 s50, s50, 0x7ffff
    s_or_b32 s32, s50, s34
    s_add_u32 m0, s35, 65536
    ds_read_b32 v125, v26
    s_setprio 3
    v_exp_f32 v48, v48
    v_cvt_pk_bf16_f32 v103, v78, v79
    v_exp_f32 v49, v49
    v_exp_f32 v50, v50
    s_waitcnt lgkmcnt(0)
    v_readfirstlane_b32 s5, v125
    v_smfmac_f32_16x16x64_bf16 v[20:23], v[16:19], v[96:103], v127
    v_exp_f32 v51, v51
    v_mfma_f32_32x32x16_bf16 v[80:95], v[116:119], v[100:103], v[80:95]
    ds_read_b128 v[116:119], v7 offset:11264
    v_cvt_pk_bf16_f32 v96, v48, v49
    v_exp_f32 v52, v52
    v_exp_f32 v53, v53
    v_cvt_pk_bf16_f32 v97, v50, v51
    s_cmp_lt_u32 s5, 8
    s_cbranch_scc1 Lool_45
Lret_46:
    v_mfma_f32_32x32x16_bf16 v[64:79], v[104:107], v[8:11], v[32:47]
    v_exp_f32 v54, v54
    v_exp_f32 v55, v55
    v_cvt_pk_bf16_f32 v98, v52, v53
    v_exp_f32 v56, v56
    v_mfma_f32_32x32x16_bf16 v[64:79], v[108:111], v[12:15], v[64:79]
    ds_read_b128 v[104:107], v3 offset:0
    ds_read_b128 v[108:111], v3 offset:1024
    v_cvt_pk_bf16_f32 v99, v54, v55
    v_exp_f32 v57, v57
    v_exp_f32 v58, v58
    v_exp_f32 v59, v59
    v_mfma_f32_32x32x16_bf16 v[80:95], v[112:115], v[96:99], v[80:95]
    ds_read_b128 v[112:115], v7 offset:14336
    v_cvt_pk_bf16_f32 v100, v56, v57
    v_exp_f32 v60, v60
    v_exp_f32 v61, v61
    v_cvt_pk_bf16_f32 v101, v58, v59
    buffer_load_dwordx4 v2, s[16:19], s32 offen offset:0 sc1 lds
    v_exp_f32 v62, v62
    v_exp_f32 v63, v63
    v_cvt_pk_bf16_f32 v102, v60, v61
    buffer_load_dwordx4 v2, s[16:19], s32 offen offset:1024 sc1 lds
    s_lshl_b32 s5, s2, 3
    s_add_u32 s5, s5, s22
    s_cmp_eq_u32 s5, 7
    s_cbranch_scc1 Lool_49
Lret_50:
    s_setprio 2
    v_exp_f32 v64, v64
    v_cvt_pk_bf16_f32 v103, v62, v63
    v_exp_f32 v65, v65
    v_exp_f32 v66, v66
    s_waitcnt lgkmcnt(0)
    buffer_load_dwordx4 v2, s[16:19], s32 offen offset:2048 sc1 lds
    v_smfmac_f32_16x16x64_bf16 v[20:23], v[16:19], v[96:103], v127
    v_exp_f32 v67, v67
    v_mfma_f32_32x32x16_bf16 v[80:95], v[116:119], v[100:103], v[80:95]
    ds_read_b128 v[116:119], v7 offset:15360
    v_cvt_pk_bf16_f32 v96, v64, v65
    v_exp_f32 v68, v68
    v_exp_f32 v69, v69
    v_cvt_pk_bf16_f32 v97, v66, v67
    s_waitcnt vmcnt(4)
    ds_add_u32 v26, v27
    v_mfma_f32_32x32x16_bf16 v[48:63], v[104:107], v[8:11], v[32:47]
    v_exp_f32 v70, v70
    v_exp_f32 v71, v71
    v_cvt_pk_bf16_f32 v98, v68, v69
    v_exp_f32 v72, v72
    v_mfma_f32_32x32x16_bf16 v[48:63], v[108:111], v[12:15], v[48:63]
    ds_read_b128 v[104:107], v3 offset:4096
    ds_read_b128 v[108:111], v3 offset:5120
    v_cvt_pk_bf16_f32 v99, v70, v71
    v_exp_f32 v73, v73
    v_exp_f32 v74, v74
    v_exp_f32 v75, v75
    v_mfma_f32_32x32x16_bf16 v[80:95], v[112:115], v[96:99], v[80:95]
    ds_read_b128 v[112:115], v3 offset:2048
    v_cvt_pk_bf16_f32 v100, v72, v73
    v_exp_f32 v76, v76
    v_exp_f32 v77, v77
    v_cvt_pk_bf16_f32 v101, v74, v75
    buffer_load_dwordx4 v2, s[16:19], s32 offen offset:3072 sc1 lds
    v_exp_f32 v78, v78
    v_exp_f32 v79, v79
    v_cvt_pk_bf16_f32 v102, v76, v77
    s_setprio 1
    v_exp_f32 v48, v48
    v_cvt_pk_bf16_f32 v103, v78, v79
    v_exp_f32 v49, v49
    v_exp_f32 v50, v50
    s_waitcnt lgkmcnt(0)
    v_smfmac_f32_16x16x64_bf16 v[20:23], v[16:19], v[96:103], v127
    v_exp_f32 v51, v51
    v_mfma_f32_32x32x16_bf16 v[80:95], v[116:119], v[100:103], v[80:95]
    ds_read_b128 v[116:119], v3 offset:3072
    v_cvt_pk_bf16_f32 v96, v48, v49
    v_exp_f32 v52, v52
    v_exp_f32 v53, v53
    v_cvt_pk_bf16_f32 v97, v50, v51
    s_add_u32 m0, s77, 114688
    s_mov_b32 s33, 0
    buffer_load_dwordx4 v120, s[68:71], s33 offen nt lds
    v_mfma_f32_32x32x16_bf16 v[64:79], v[104:107], v[8:11], v[32:47]
    v_exp_f32 v54, v54
    v_exp_f32 v55, v55
    v_cvt_pk_bf16_f32 v98, v52, v53
    v_exp_f32 v56, v56
    v_mfma_f32_32x32x16_bf16 v[64:79], v[108:111], v[12:15], v[64:79]
    ds_read_b128 v[104:107], v3 offset:8192
    ds_read_b128 v[108:111], v3 offset:9216
    v_cvt_pk_bf16_f32 v99, v54, v55
    v_exp_f32 v57, v57
    v_exp_f32 v58, v58
    v_exp_f32 v59, v59
    v_mfma_f32_32x32x16_bf16 v[80:95], v[112:115], v[96:99], v[80:95]
    ds_read_b128 v[112:115], v3 offset:6144
    v_cvt_pk_bf16_f32 v100, v56, v57
    v_exp_f32 v60, v60
    v_exp_f32 v61, v61
    v_cvt_pk_bf16_f32 v101, v58, v59
    v_exp_f32 v62, v62
    v_exp_f32 v63, v63
    v_cvt_pk_bf16_f32 v102, v60, v61
    s_setprio 0
    v_exp_f32 v64, v64
    v_cvt_pk_bf16_f32 v103, v62, v63
    v_exp_f32 v65, v65
    v_exp_f32 v66, v66
    s_waitcnt lgkmcnt(0)
    s_waitcnt vmcnt(5)
    ds_read_b64_tr_b16 v[200:201], v25 offset:8192
    ds_read_b64_tr_b16 v[202:203], v25 offset:8704
    v_smfmac_f32_16x16x64_bf16 v[20:23], v[16:19], v[96:103], v127
    v_exp_f32 v67, v67
    v_mfma_f32_32x32x16_bf16 v[80:95], v[116:119], v[100:103], v[80:95]
    ds_read_b128 v[116:119], v3 offset:7168
    v_cvt_pk_bf16_f32 v96, v64, v65
    v_exp_f32 v68, v68
    v_exp_f32 v69, v69
    v_cvt_pk_bf16_f32 v97, v66, v67
    v_mfma_f32_32x32x16_bf16 v[48:63], v[104:107], v[8:11], v[32:47]
    v_exp_f32 v70, v70
    v_exp_f32 v71, v71
    v_cvt_pk_bf16_f32 v98, v68, v69
    v_exp_f32 v72, v72
    v_mfma_f32_32x32x16_bf16 v[48:63], v[108:111], v[12:15], v[48:63]
    ds_read_b128 v[104:107], v3 offset:12288
    ds_read_b128 v[108:111], v3 offset:13312
    v_cvt_pk_bf16_f32 v99, v70, v71
    v_exp_f32 v73, v73
    v_exp_f32 v74, v74
    v_exp_f32 v75, v75
    v_mfma_f32_32x32x16_bf16 v[80:95], v[112:115], v[96:99], v[80:95]
    ds_read_b128 v[112:115], v3 offset:10240
    v_cvt_pk_bf16_f32 v100, v72, v73
    v_exp_f32 v76, v76
    v_exp_f32 v77, v77
    v_cvt_pk_bf16_f32 v101, v74, v75
    v_exp_f32 v78, v78
    v_exp_f32 v79, v79
    v_cvt_pk_bf16_f32 v102, v76, v77
    s_add_u32 s50, s50, 32768
    s_and_b32 s50, s50, 0x7ffff
    s_or_b32 s32, s50, s34
    s_add_u32 m0, s35, 131072
    ds_read_b32 v125, v26
    s_setprio 3
    v_exp_f32 v48, v48
    v_cvt_pk_bf16_f32 v103, v78, v79
    v_exp_f32 v49, v49
    v_exp_f32 v50, v50
    s_waitcnt lgkmcnt(0)
    v_readfirstlane_b32 s5, v125
    v_smfmac_f32_16x16x64_bf16 v[20:23], v[16:19], v[96:103], v127
    v_exp_f32 v51, v51
    v_mfma_f32_32x32x16_bf16 v[80:95], v[116:119], v[100:103], v[80:95]
    ds_read_b128 v[116:119], v3 offset:11264
    v_cvt_pk_bf16_f32 v96, v48, v49
    v_exp_f32 v52, v52
    v_exp_f32 v53, v53
    v_cvt_pk_bf16_f32 v97, v50, v51
    s_cmp_lt_u32 s5, 16
    s_cbranch_scc1 Lool_54
Lret_55:
    s_add_u32 s5, s47, s28
    s_lshl_b32 s6, s5, 10
    s_add_u32 s6, s6, 0x1600000
    buffer_store_dwordx4 v[200:203], v1, s[16:19], s6 offen sc1
    v_mfma_f32_32x32x16_bf16 v[64:79], v[104:107], v[8:11], v[32:47]
    v_exp_f32 v54, v54
    v_exp_f32 v55, v55
    v_cvt_pk_bf16_f32 v98, v52, v53
    v_exp_f32 v56, v56
    v_mfma_f32_32x32x16_bf16 v[64:79], v[108:111], v[12:15], v[64:79]
    ds_read_b128 v[104:107], v3 offset:32768
    ds_read_b128 v[108:111], v3 offset:33792
    v_cvt_pk_bf16_f32 v99, v54, v55
    v_exp_f32 v57, v57
    v_exp_f32 v58, v58
    v_exp_f32 v59, v59
    v_mfma_f32_32x32x16_bf16 v[80:95], v[112:115], v[96:99], v[80:95]
    ds_read_b128 v[112:115], v3 offset:14336
    v_cvt_pk_bf16_f32 v100, v56, v57
    v_exp_f32 v60, v60
    v_exp_f32 v61, v61
    v_cvt_pk_bf16_f32 v101, v58, v59
    buffer_load_dwordx4 v2, s[16:19], s32 offen offset:0 sc1 lds
    v_exp_f32 v62, v62
    v_exp_f32 v63, v63
    v_cvt_pk_bf16_f32 v102, v60, v61
    buffer_load_dwordx4 v2, s[16:19], s32 offen offset:1024 sc1 lds
    s_setprio 2
    v_exp_f32 v64, v64
    v_cvt_pk_bf16_f32 v103, v62, v63
    v_exp_f32 v65, v65
    v_exp_f32 v66, v66
    s_waitcnt lgkmcnt(0)
    buffer_load_dwordx4 v2, s[16:19], s32 offen offset:2048 sc1 lds
    v_smfmac_f32_16x16x64_bf16 v[20:23], v[16:19], v[96:103], v127
    v_exp_f32 v67, v67
    v_mfma_f32_32x32x16_bf16 v[80:95], v[116:119], v[100:103], v[80:95]
    ds_read_b128 v[116:119], v3 offset:15360
    v_cvt_pk_bf16_f32 v96, v64, v65
    v_exp_f32 v68, v68
    v_exp_f32 v69, v69
    v_cvt_pk_bf16_f32 v97, v66, v67
    s_waitcnt vmcnt(5)
    ds_add_u32 v26, v27
    v_mfma_f32_32x32x16_bf16 v[48:63], v[104:107], v[8:11], v[32:47]
    v_exp_f32 v70, v70
    v_exp_f32 v71, v71
    v_cvt_pk_bf16_f32 v98, v68, v69
    v_exp_f32 v72, v72
    v_mfma_f32_32x32x16_bf16 v[48:63], v[108:111], v[12:15], v[48:63]
    ds_read_b128 v[104:107], v3 offset:36864
    ds_read_b128 v[108:111], v3 offset:37888
    v_cvt_pk_bf16_f32 v99, v70, v71
    v_exp_f32 v73, v73
    v_exp_f32 v74, v74
    v_exp_f32 v75, v75
    v_mfma_f32_32x32x16_bf16 v[80:95], v[112:115], v[96:99], v[80:95]
    ds_read_b128 v[112:115], v3 offset:34816
    v_cvt_pk_bf16_f32 v100, v72, v73
    v_exp_f32 v76, v76
    v_exp_f32 v77, v77
    v_cvt_pk_bf16_f32 v101, v74, v75
    buffer_load_dwordx4 v2, s[16:19], s32 offen offset:3072 sc1 lds
    s_mov_b32 s83, 0x1000800
    v_mov_b32 v4, 0
    buffer_load_dwordx2 v[30:31], v4, s[16:19], s83 offen sc1
    v_exp_f32 v78, v78
    v_exp_f32 v79, v79
    v_cvt_pk_bf16_f32 v102, v76, v77
    s_setprio 1
    v_exp_f32 v48, v48
    v_cvt_pk_bf16_f32 v103, v78, v79
    v_exp_f32 v49, v49
    v_exp_f32 v50, v50
    s_waitcnt lgkmcnt(0)
    v_smfmac_f32_16x16x64_bf16 v[20:23], v[16:19], v[96:103], v127
    v_exp_f32 v51, v51
    v_mfma_f32_32x32x16_bf16 v[80:95], v[116:119], v[100:103], v[80:95]
    ds_read_b128 v[116:119], v3 offset:35840
    v_cvt_pk_bf16_f32 v96, v48, v49
    v_exp_f32 v52, v52
    v_exp_f32 v53, v53
    v_cvt_pk_bf16_f32 v97, v50, v51
    s_add_u32 m0, s77, 122880
    s_mov_b32 s33, 114688
    buffer_load_dwordx4 v120, s[68:71], s33 offen nt lds
    v_mfma_f32_32x32x16_bf16 v[64:79], v[104:107], v[8:11], v[32:47]
    v_exp_f32 v54, v54
    v_exp_f32 v55, v55
    v_cvt_pk_bf16_f32 v98, v52, v53
    v_exp_f32 v56, v56
    v_mfma_f32_32x32x16_bf16 v[64:79], v[108:111], v[12:15], v[64:79]
    ds_read_b128 v[104:107], v3 offset:40960
    ds_read_b128 v[108:111], v3 offset:41984
    v_cvt_pk_bf16_f32 v99, v54, v55
    v_exp_f32 v57, v57
    v_exp_f32 v58, v58
    v_exp_f32 v59, v59
    v_mfma_f32_32x32x16_bf16 v[80:95], v[112:115], v[96:99], v[80:95]
    ds_read_b128 v[112:115], v3 offset:38912
    v_cvt_pk_bf16_f32 v100, v56, v57
    v_exp_f32 v60, v60
    v_exp_f32 v61, v61
    v_cvt_pk_bf16_f32 v101, v58, v59
    v_exp_f32 v62, v62
    v_exp_f32 v63, v63
    v_cvt_pk_bf16_f32 v102, v60, v61
    s_setprio 0
    v_exp_f32 v64, v64
    v_cvt_pk_bf16_f32 v103, v62, v63
    v_exp_f32 v65, v65
    v_exp_f32 v66, v66
    s_waitcnt lgkmcnt(0)
    v_smfmac_f32_16x16x64_bf16 v[20:23], v[16:19], v[96:103], v127
    v_exp_f32 v67, v67
    v_mfma_f32_32x32x16_bf16 v[80:95], v[116:119], v[100:103], v[80:95]
    ds_read_b128 v[116:119], v3 offset:39936
    v_cvt_pk_bf16_f32 v96, v64, v65
    v_exp_f32 v68, v68
    v_exp_f32 v69, v69
    v_cvt_pk_bf16_f32 v97, v66, v67
    s_add_u32 s5, s47, s28
    s_lshl_b32 s5, s5, 2
    s_add_u32 s5, s5, 0x100d000
    v_mov_b32 v4, 0
    v_mov_b32 v5, s25
    s_waitcnt vmcnt(6)
    s_mov_b64 exec, 1
    buffer_store_dword v5, v4, s[16:19], s5 offen sc1
    s_mov_b64 exec, -1
    s_add_u32 m0, s77, 106496
    s_mov_b32 s33, 229376
    buffer_load_dwordx4 v120, s[68:71], s33 offen nt lds
    v_mfma_f32_32x32x16_bf16 v[48:63], v[104:107], v[8:11], v[32:47]
    v_exp_f32 v70, v70
    v_exp_f32 v71, v71
    v_cvt_pk_bf16_f32 v98, v68, v69
    v_exp_f32 v72, v72
    v_mfma_f32_32x32x16_bf16 v[48:63], v[108:111], v[12:15], v[48:63]
    ds_read_b128 v[104:107], v3 offset:45056
    ds_read_b128 v[108:111], v3 offset:46080
    v_cvt_pk_bf16_f32 v99, v70, v71
    v_exp_f32 v73, v73
    v_exp_f32 v74, v74
    v_exp_f32 v75, v75
    v_mfma_f32_32x32x16_bf16 v[80:95], v[112:115], v[96:99], v[80:95]
    ds_read_b128 v[112:115], v3 offset:43008
    v_cvt_pk_bf16_f32 v100, v72, v73
    v_exp_f32 v76, v76
    v_exp_f32 v77, v77
    v_cvt_pk_bf16_f32 v101, v74, v75
    v_exp_f32 v78, v78
    v_exp_f32 v79, v79
    v_cvt_pk_bf16_f32 v102, v76, v77
    s_add_u32 s50, s50, 32768
    s_and_b32 s50, s50, 0x7ffff
    s_or_b32 s32, s50, s34
    s_add_u32 m0, s35, 0
    ds_read_b32 v125, v26
    s_setprio 3
    v_exp_f32 v48, v48
    v_cvt_pk_bf16_f32 v103, v78, v79
    v_exp_f32 v49, v49
    v_exp_f32 v50, v50
    s_waitcnt lgkmcnt(0)
    v_readfirstlane_b32 s5, v125
    s_waitcnt vmcnt(3)
    v_readfirstlane_b32 s27, v30
    v_readfirstlane_b32 s96, v31
    v_smfmac_f32_16x16x64_bf16 v[20:23], v[16:19], v[96:103], v127
    v_exp_f32 v51, v51
    v_mfma_f32_32x32x16_bf16 v[80:95], v[116:119], v[100:103], v[80:95]
    ds_read_b128 v[116:119], v3 offset:44032
    v_cvt_pk_bf16_f32 v96, v48, v49
    v_exp_f32 v52, v52
    v_exp_f32 v53, v53
    v_cvt_pk_bf16_f32 v97, v50, v51
    s_cmp_lt_u32 s5, 24
    s_cbranch_scc1 Lool_58
Lret_59:
    s_cmp_lg_u32 s96, s25
    s_cbranch_scc1 Lool_62
Lret_63:
    s_and_b32 s26, s27, 0xffff
    s_sub_u32 s26, 2047, s26
    s_and_b32 s26, s26, 2047
    s_mul_hi_u32 s5, s93, 0x924924A
    s_min_u32 s5, s5, 7
    s_lshl_b32 s5, s5, 8
    s_lshl_b32 s97, s26, 11
    s_add_u32 s97, s97, s5
    v_mfma_f32_32x32x16_bf16 v[64:79], v[104:107], v[8:11], v[32:47]
    v_exp_f32 v54, v54
    v_exp_f32 v55, v55
    v_cvt_pk_bf16_f32 v98, v52, v53
    v_exp_f32 v56, v56
    v_mfma_f32_32x32x16_bf16 v[64:79], v[108:111], v[12:15], v[64:79]
    ds_read_b128 v[104:107], v6 offset:0
    ds_read_b128 v[108:111], v6 offset:1024
    v_cvt_pk_bf16_f32 v99, v54, v55
    v_exp_f32 v57, v57
    v_exp_f32 v58, v58
    v_exp_f32 v59, v59
    v_mfma_f32_32x32x16_bf16 v[80:95], v[112:115], v[96:99], v[80:95]
    ds_read_b128 v[112:115], v3 offset:47104
    v_cvt_pk_bf16_f32 v100, v56, v57
    v_exp_f32 v60, v60
    v_exp_f32 v61, v61
    v_cvt_pk_bf16_f32 v101, v58, v59
    buffer_load_dwordx4 v2, s[16:19], s32 offen offset:0 sc1 lds
    buffer_load_dwordx2 v[232:233], v123, s[8:11], s97 offen offset:0
    buffer_load_dwordx2 v[234:235], v123, s[8:11], s97 offen offset:16
    v_exp_f32 v62, v62
    v_exp_f32 v63, v63
    v_cvt_pk_bf16_f32 v102, v60, v61
    buffer_load_dwordx4 v2, s[16:19], s32 offen offset:1024 sc1 lds
    s_setprio 2
    v_exp_f32 v64, v64
    v_cvt_pk_bf16_f32 v103, v62, v63
    v_exp_f32 v65, v65
    v_exp_f32 v66, v66
    s_waitcnt lgkmcnt(0)
    buffer_load_dwordx4 v2, s[16:19], s32 offen offset:2048 sc1 lds
    ds_read_b64_tr_b16 v[200:201], v25 offset:16384
    ds_read_b64_tr_b16 v[202:203], v25 offset:16896
    v_smfmac_f32_16x16x64_bf16 v[20:23], v[16:19], v[96:103], v127
    v_exp_f32 v67, v67
    v_mfma_f32_32x32x16_bf16 v[80:95], v[116:119], v[100:103], v[80:95]
    ds_read_b128 v[116:119], v3 offset:48128
    v_cvt_pk_bf16_f32 v96, v64, v65
    v_exp_f32 v68, v68
    v_exp_f32 v69, v69
    v_cvt_pk_bf16_f32 v97, v66, v67
    ds_add_u32 v26, v27
    v_mfma_f32_32x32x16_bf16 v[48:63], v[104:107], v[8:11], v[32:47]
    v_exp_f32 v70, v70
    v_exp_f32 v71, v71
    v_cvt_pk_bf16_f32 v98, v68, v69
    v_exp_f32 v72, v72
    v_mfma_f32_32x32x16_bf16 v[48:63], v[108:111], v[12:15], v[48:63]
    ds_read_b128 v[104:107], v6 offset:4096
    ds_read_b128 v[108:111], v6 offset:5120
    v_cvt_pk_bf16_f32 v99, v70, v71
    v_exp_f32 v73, v73
    v_exp_f32 v74, v74
    v_exp_f32 v75, v75
    v_mfma_f32_32x32x16_bf16 v[80:95], v[112:115], v[96:99], v[80:95]
    ds_read_b128 v[112:115], v6 offset:2048
    v_cvt_pk_bf16_f32 v100, v72, v73
    v_exp_f32 v76, v76
    v_exp_f32 v77, v77
    v_cvt_pk_bf16_f32 v101, v74, v75
    buffer_load_dwordx4 v2, s[16:19], s32 offen offset:3072 sc1 lds
    v_exp_f32 v78, v78
    v_exp_f32 v79, v79
    v_cvt_pk_bf16_f32 v102, v76, v77
    s_setprio 1
    v_exp_f32 v48, v48
    v_cvt_pk_bf16_f32 v103, v78, v79
    v_exp_f32 v49, v49
    v_exp_f32 v50, v50
    s_waitcnt lgkmcnt(0)
    v_smfmac_f32_16x16x64_bf16 v[20:23], v[16:19], v[96:103], v127
    v_exp_f32 v51, v51
    v_mfma_f32_32x32x16_bf16 v[80:95], v[116:119], v[100:103], v[80:95]
    ds_read_b128 v[116:119], v6 offset:3072
    v_cvt_pk_bf16_f32 v96, v48, v49
    v_exp_f32 v52, v52
    v_exp_f32 v53, v53
    v_cvt_pk_bf16_f32 v97, v50, v51
    s_add_u32 m0, s77, 114688
    s_mov_b32 s33, 344064
    buffer_load_dwordx4 v120, s[68:71], s33 offen nt lds
    v_mfma_f32_32x32x16_bf16 v[64:79], v[104:107], v[8:11], v[32:47]
    v_exp_f32 v54, v54
    v_exp_f32 v55, v55
    v_cvt_pk_bf16_f32 v98, v52, v53
    v_exp_f32 v56, v56
    v_mfma_f32_32x32x16_bf16 v[64:79], v[108:111], v[12:15], v[64:79]
    ds_read_b128 v[104:107], v6 offset:8192
    ds_read_b128 v[108:111], v6 offset:9216
    v_cvt_pk_bf16_f32 v99, v54, v55
    v_exp_f32 v57, v57
    v_exp_f32 v58, v58
    v_exp_f32 v59, v59
    v_mfma_f32_32x32x16_bf16 v[80:95], v[112:115], v[96:99], v[80:95]
    ds_read_b128 v[112:115], v6 offset:6144
    v_cvt_pk_bf16_f32 v100, v56, v57
    v_exp_f32 v60, v60
    v_exp_f32 v61, v61
    v_cvt_pk_bf16_f32 v101, v58, v59
    buffer_load_dwordx2 v[236:237], v123, s[8:11], s97 offen offset:32
    buffer_load_dwordx2 v[238:239], v123, s[8:11], s97 offen offset:48
    v_exp_f32 v62, v62
    v_exp_f32 v63, v63
    v_cvt_pk_bf16_f32 v102, v60, v61
    s_waitcnt vmcnt(6)
    v_mfma_f32_32x32x16_bf16 v[240:255], v[232:235], v[200:203], 0
    s_setprio 0
    v_exp_f32 v64, v64
    v_cvt_pk_bf16_f32 v103, v62, v63
    v_exp_f32 v65, v65
    v_exp_f32 v66, v66
    s_waitcnt lgkmcnt(0)
    ds_read_b64_tr_b16 v[200:201], v25 offset:24576
    ds_read_b64_tr_b16 v[202:203], v25 offset:25088
    v_smfmac_f32_16x16x64_bf16 v[20:23], v[16:19], v[96:103], v127
    v_exp_f32 v67, v67
    v_mfma_f32_32x32x16_bf16 v[80:95], v[116:119], v[100:103], v[80:95]
    ds_read_b128 v[116:119], v6 offset:7168
    v_cvt_pk_bf16_f32 v96, v64, v65
    v_exp_f32 v68, v68
    v_exp_f32 v69, v69
    v_cvt_pk_bf16_f32 v97, v66, v67
    v_mfma_f32_32x32x16_bf16 v[48:63], v[104:107], v[8:11], v[32:47]
    v_exp_f32 v70, v70
    v_exp_f32 v71, v71
    v_cvt_pk_bf16_f32 v98, v68, v69
    v_exp_f32 v72, v72
    v_mfma_f32_32x32x16_bf16 v[48:63], v[108:111], v[12:15], v[48:63]
    ds_read_b128 v[104:107], v6 offset:12288
    ds_read_b128 v[108:111], v6 offset:13312
    v_cvt_pk_bf16_f32 v99, v70, v71
    v_exp_f32 v73, v73
    v_exp_f32 v74, v74
    v_exp_f32 v75, v75
    v_mfma_f32_32x32x16_bf16 v[80:95], v[112:115], v[96:99], v[80:95]
    ds_read_b128 v[112:115], v6 offset:10240
    v_cvt_pk_bf16_f32 v100, v72, v73
    v_exp_f32 v76, v76
    v_exp_f32 v77, v77
    v_cvt_pk_bf16_f32 v101, v74, v75
    v_mov_b32 v224, -1
    v_mov_b32 v225, -1
    v_mov_b32 v226, -1
    v_mov_b32 v227, -1
    buffer_store_dwordx4 v[224:227], v1, s[16:19], s73 offen sc1
    buffer_store_dwordx4 v[224:227], v1, s[16:19], s73 offen offset:1024 sc1
    v_exp_f32 v78, v78
    v_exp_f32 v79, v79
    v_cvt_pk_bf16_f32 v102, v76, v77
    s_add_u32 s50, s50, 32768
    s_and_b32 s50, s50, 0x7ffff
    s_or_b32 s32, s50, s34
    s_add_u32 m0, s35, 32768
    ds_read_b32 v125, v26
    s_setprio 3
    v_exp_f32 v48, v48
    v_cvt_pk_bf16_f32 v103, v78, v79
    v_exp_f32 v49, v49
    v_exp_f32 v50, v50
    s_waitcnt lgkmcnt(0)
    v_readfirstlane_b32 s5, v125
    v_smfmac_f32_16x16x64_bf16 v[20:23], v[16:19], v[96:103], v127
    v_exp_f32 v51, v51
    v_mfma_f32_32x32x16_bf16 v[80:95], v[116:119], v[100:103], v[80:95]
    ds_read_b128 v[116:119], v6 offset:11264
    v_cvt_pk_bf16_f32 v96, v48, v49
    v_exp_f32 v52, v52
    v_exp_f32 v53, v53
    v_cvt_pk_bf16_f32 v97, v50, v51
    s_cmp_lt_u32 s5, 32
    s_cbranch_scc1 Lool_66
Lret_67:
    v_mfma_f32_32x32x16_bf16 v[64:79], v[104:107], v[8:11], v[32:47]
    v_exp_f32 v54, v54
    v_exp_f32 v55, v55
    v_cvt_pk_bf16_f32 v98, v52, v53
    v_exp_f32 v56, v56
    v_mfma_f32_32x32x16_bf16 v[64:79], v[108:111], v[12:15], v[64:79]
    ds_read_b128 v[104:107], v7 offset:0
    ds_read_b128 v[108:111], v7 offset:1024
    v_cvt_pk_bf16_f32 v99, v54, v55
    v_exp_f32 v57, v57
    v_exp_f32 v58, v58
    v_exp_f32 v59, v59
    v_mfma_f32_32x32x16_bf16 v[80:95], v[112:115], v[96:99], v[80:95]
    ds_read_b128 v[112:115], v6 offset:14336
    v_cvt_pk_bf16_f32 v100, v56, v57
    v_exp_f32 v60, v60
    v_exp_f32 v61, v61
    v_cvt_pk_bf16_f32 v101, v58, v59
    buffer_load_dwordx4 v2, s[16:19], s32 offen offset:0 sc1 lds
    buffer_load_dwordx2 v[232:233], v123, s[8:11], s97 offen offset:64
    buffer_load_dwordx2 v[234:235], v123, s[8:11], s97 offen offset:80
    v_exp_f32 v62, v62
    v_exp_f32 v63, v63
    v_cvt_pk_bf16_f32 v102, v60, v61
    buffer_load_dwordx4 v2, s[16:19], s32 offen offset:1024 sc1 lds
    s_waitcnt vmcnt(6)
    v_mfma_f32_32x32x16_bf16 v[240:255], v[236:239], v[200:203], v[240:255]
    s_setprio 2
    v_exp_f32 v64, v64
    v_cvt_pk_bf16_f32 v103, v62, v63
    v_exp_f32 v65, v65
    v_exp_f32 v66, v66
    s_waitcnt lgkmcnt(0)
    buffer_load_dwordx4 v2, s[16:19], s32 offen offset:2048 sc1 lds
    ds_read_b64_tr_b16 v[200:201], v25 offset:8192
    ds_read_b64_tr_b16 v[202:203], v25 offset:8704
    v_smfmac_f32_16x16x64_bf16 v[20:23], v[16:19], v[96:103], v127
    v_exp_f32 v67, v67
    v_mfma_f32_32x32x16_bf16 v[80:95], v[116:119], v[100:103], v[80:95]
    ds_read_b128 v[116:119], v6 offset:15360
    v_cvt_pk_bf16_f32 v96, v64, v65
    v_exp_f32 v68, v68
    v_exp_f32 v69, v69
    v_cvt_pk_bf16_f32 v97, v66, v67
    ds_add_u32 v26, v27
    v_mfma_f32_32x32x16_bf16 v[48:63], v[104:107], v[8:11], v[32:47]
    v_exp_f32 v70, v70
    v_exp_f32 v71, v71
    v_cvt_pk_bf16_f32 v98, v68, v69
    v_exp_f32 v72, v72
    v_mfma_f32_32x32x16_bf16 v[48:63], v[108:111], v[12:15], v[48:63]
    ds_read_b128 v[104:107], v7 offset:4096
    ds_read_b128 v[108:111], v7 offset:5120
    v_cvt_pk_bf16_f32 v99, v70, v71
    v_exp_f32 v73, v73
    v_exp_f32 v74, v74
    v_exp_f32 v75, v75
    v_mfma_f32_32x32x16_bf16 v[80:95], v[112:115], v[96:99], v[80:95]
    ds_read_b128 v[112:115], v7 offset:2048
    v_cvt_pk_bf16_f32 v100, v72, v73
    v_exp_f32 v76, v76
    v_exp_f32 v77, v77
    v_cvt_pk_bf16_f32 v101, v74, v75
    buffer_load_dwordx4 v2, s[16:19], s32 offen offset:3072 sc1 lds
    v_exp_f32 v78, v78
    v_exp_f32 v79, v79
    v_cvt_pk_bf16_f32 v102, v76, v77
    s_setprio 1
    v_exp_f32 v48, v48
    v_cvt_pk_bf16_f32 v103, v78, v79
    v_exp_f32 v49, v49
    v_exp_f32 v50, v50
    s_waitcnt lgkmcnt(0)
    v_smfmac_f32_16x16x64_bf16 v[20:23], v[16:19], v[96:103], v127
    v_exp_f32 v51, v51
    v_mfma_f32_32x32x16_bf16 v[80:95], v[116:119], v[100:103], v[80:95]
    ds_read_b128 v[116:119], v7 offset:3072
    v_cvt_pk_bf16_f32 v96, v48, v49
    v_exp_f32 v52, v52
    v_exp_f32 v53, v53
    v_cvt_pk_bf16_f32 v97, v50, v51
    s_add_u32 m0, s77, 122880
    s_mov_b32 s33, 458752
    buffer_load_dwordx4 v120, s[68:71], s33 offen nt lds
    v_mfma_f32_32x32x16_bf16 v[64:79], v[104:107], v[8:11], v[32:47]
    v_exp_f32 v54, v54
    v_exp_f32 v55, v55
    v_cvt_pk_bf16_f32 v98, v52, v53
    v_exp_f32 v56, v56
    v_mfma_f32_32x32x16_bf16 v[64:79], v[108:111], v[12:15], v[64:79]
    ds_read_b128 v[104:107], v7 offset:8192
    ds_read_b128 v[108:111], v7 offset:9216
    v_cvt_pk_bf16_f32 v99, v54, v55
    v_exp_f32 v57, v57
    v_exp_f32 v58, v58
    v_exp_f32 v59, v59
    v_mfma_f32_32x32x16_bf16 v[80:95], v[112:115], v[96:99], v[80:95]
    ds_read_b128 v[112:115], v7 offset:6144
    v_cvt_pk_bf16_f32 v100, v56, v57
    v_exp_f32 v60, v60
    v_exp_f32 v61, v61
    v_cvt_pk_bf16_f32 v101, v58, v59
    buffer_load_dwordx2 v[236:237], v123, s[8:11], s97 offen offset:96
    buffer_load_dwordx2 v[238:239], v123, s[8:11], s97 offen offset:112
    v_exp_f32 v62, v62
    v_exp_f32 v63, v63
    v_cvt_pk_bf16_f32 v102, v60, v61
    s_waitcnt vmcnt(6)
    v_mfma_f32_32x32x16_bf16 v[240:255], v[232:235], v[200:203], v[240:255]
    s_setprio 0
    v_exp_f32 v64, v64
    v_cvt_pk_bf16_f32 v103, v62, v63
    v_exp_f32 v65, v65
    v_exp_f32 v66, v66
    s_waitcnt lgkmcnt(0)
    ds_read_b64_tr_b16 v[200:201], v25 offset:16384
    ds_read_b64_tr_b16 v[202:203], v25 offset:16896
    v_smfmac_f32_16x16x64_bf16 v[20:23], v[16:19], v[96:103], v127
    v_exp_f32 v67, v67
    v_mfma_f32_32x32x16_bf16 v[80:95], v[116:119], v[100:103], v[80:95]
    ds_read_b128 v[116:119], v7 offset:7168
    v_cvt_pk_bf16_f32 v96, v64, v65
    v_exp_f32 v68, v68
    v_exp_f32 v69, v69
    v_cvt_pk_bf16_f32 v97, v66, v67
    s_add_u32 m0, s77, 106496
    s_mov_b32 s33, 573440
    buffer_load_dwordx4 v120, s[68:71], s33 offen nt lds
    v_mfma_f32_32x32x16_bf16 v[48:63], v[104:107], v[8:11], v[32:47]
    v_exp_f32 v70, v70
    v_exp_f32 v71, v71
    v_cvt_pk_bf16_f32 v98, v68, v69
    v_exp_f32 v72, v72
    v_mfma_f32_32x32x16_bf16 v[48:63], v[108:111], v[12:15], v[48:63]
    ds_read_b128 v[104:107], v7 offset:12288
    ds_read_b128 v[108:111], v7 offset:13312
    v_cvt_pk_bf16_f32 v99, v70, v71
    v_exp_f32 v73, v73
    v_exp_f32 v74, v74
    v_exp_f32 v75, v75
    v_mfma_f32_32x32x16_bf16 v[80:95], v[112:115], v[96:99], v[80:95]
    ds_read_b128 v[112:115], v7 offset:10240
    v_cvt_pk_bf16_f32 v100, v72, v73
    v_exp_f32 v76, v76
    v_exp_f32 v77, v77
    v_cvt_pk_bf16_f32 v101, v74, v75
    v_exp_f32 v78, v78
    v_exp_f32 v79, v79
    v_cvt_pk_bf16_f32 v102, v76, v77
    s_add_u32 s50, s50, 32768
    s_and_b32 s50, s50, 0x7ffff
    s_or_b32 s32, s50, s34
    s_add_u32 m0, s35, 65536
    s_memrealtime s[88:89]
    ds_read_b32 v125, v26
    s_setprio 3
    v_exp_f32 v48, v48
    v_cvt_pk_bf16_f32 v103, v78, v79
    v_exp_f32 v49, v49
    v_exp_f32 v50, v50
    s_waitcnt lgkmcnt(0)
    v_readfirstlane_b32 s5, v125
    v_smfmac_f32_16x16x64_bf16 v[20:23], v[16:19], v[96:103], v127
    v_exp_f32 v51, v51
    v_mfma_f32_32x32x16_bf16 v[80:95], v[116:119], v[100:103], v[80:95]
    ds_read_b128 v[116:119], v7 offset:11264
    v_cvt_pk_bf16_f32 v96, v48, v49
    v_exp_f32 v52, v52
    v_exp_f32 v53, v53
    v_cvt_pk_bf16_f32 v97, v50, v51
    s_cmp_lt_u32 s5, 40
    s_cbranch_scc1 Lool_70
Lret_71:
    v_mfma_f32_32x32x16_bf16 v[64:79], v[104:107], v[8:11], v[32:47]
    v_exp_f32 v54, v54
    v_exp_f32 v55, v55
    v_cvt_pk_bf16_f32 v98, v52, v53
    v_exp_f32 v56, v56
    v_mfma_f32_32x32x16_bf16 v[64:79], v[108:111], v[12:15], v[64:79]
    ds_read_b128 v[104:107], v3 offset:0
    ds_read_b128 v[108:111], v3 offset:1024
    v_cvt_pk_bf16_f32 v99, v54, v55
    v_exp_f32 v57, v57
    v_exp_f32 v58, v58
    v_exp_f32 v59, v59
    v_mfma_f32_32x32x16_bf16 v[80:95], v[112:115], v[96:99], v[80:95]
    ds_read_b128 v[112:115], v7 offset:14336
    v_cvt_pk_bf16_f32 v100, v56, v57
    v_exp_f32 v60, v60
    v_exp_f32 v61, v61
    v_cvt_pk_bf16_f32 v101, v58, v59
    buffer_load_dwordx4 v2, s[16:19], s32 offen offset:0 sc1 lds
    s_xor_b32 s5, s25, 1
    v_mov_b32 v30, s5
    v_mov_b32 v31, s88
    v_mov_b32 v4, 0
    s_mov_b64 exec, 1
    buffer_store_dwordx2 v[30:31], v4, s[16:19], s95 offen sc1
    s_mov_b64 exec, -1
    v_exp_f32 v62, v62
    v_exp_f32 v63, v63
    v_cvt_pk_bf16_f32 v102, v60, v61
    buffer_load_dwordx4 v2, s[16:19], s32 offen offset:1024 sc1 lds
    s_waitcnt vmcnt(4)
    v_mfma_f32_32x32x16_bf16 v[240:255], v[236:239], v[200:203], v[240:255]
    s_setprio 2
    v_exp_f32 v64, v64
    v_cvt_pk_bf16_f32 v103, v62, v63
    v_exp_f32 v65, v65
    v_exp_f32 v66, v66
    s_waitcnt lgkmcnt(0)
    buffer_load_dwordx4 v2, s[16:19], s32 offen offset:2048 sc1 lds
    v_smfmac_f32_16x16x64_bf16 v[20:23], v[16:19], v[96:103], v127
    v_exp_f32 v67, v67
    v_mfma_f32_32x32x16_bf16 v[80:95], v[116:119], v[100:103], v[80:95]
    ds_read_b128 v[116:119], v7 offset:15360
    v_cvt_pk_bf16_f32 v96, v64, v65
    v_exp_f32 v68, v68
    v_exp_f32 v69, v69
    v_cvt_pk_bf16_f32 v97, v66, v67
    ds_add_u32 v26, v27
    v_mfma_f32_32x32x16_bf16 v[48:63], v[104:107], v[8:11], v[32:47]
    v_exp_f32 v70, v70
    v_exp_f32 v71, v71
    v_cvt_pk_bf16_f32 v98, v68, v69
    v_exp_f32 v72, v72
    v_mfma_f32_32x32x16_bf16 v[48:63], v[108:111], v[12:15], v[48:63]
    ds_read_b128 v[104:107], v3 offset:4096
    ds_read_b128 v[108:111], v3 offset:5120
    v_cvt_pk_bf16_f32 v99, v70, v71
    v_exp_f32 v73, v73
    v_exp_f32 v74, v74
    v_exp_f32 v75, v75
    v_mfma_f32_32x32x16_bf16 v[80:95], v[112:115], v[96:99], v[80:95]
    ds_read_b128 v[112:115], v3 offset:2048
    v_cvt_pk_bf16_f32 v100, v72, v73
    v_exp_f32 v76, v76
    v_exp_f32 v77, v77
    v_cvt_pk_bf16_f32 v101, v74, v75
    buffer_load_dwordx4 v2, s[16:19], s32 offen offset:3072 sc1 lds
    buffer_load_dwordx2 v[232:233], v123, s[8:11], s97 offen offset:128
    buffer_load_dwordx2 v[234:235], v123, s[8:11], s97 offen offset:144
    v_exp_f32 v78, v78
    v_exp_f32 v79, v79
    v_cvt_pk_bf16_f32 v102, v76, v77
    s_setprio 1
    v_exp_f32 v48, v48
    v_cvt_pk_bf16_f32 v103, v78, v79
    v_exp_f32 v49, v49
    v_exp_f32 v50, v50
    s_waitcnt lgkmcnt(0)
    ds_read_b64_tr_b16 v[200:201], v25 offset:24576
    ds_read_b64_tr_b16 v[202:203], v25 offset:25088
    v_smfmac_f32_16x16x64_bf16 v[20:23], v[16:19], v[96:103], v127
    v_exp_f32 v51, v51
    v_mfma_f32_32x32x16_bf16 v[80:95], v[116:119], v[100:103], v[80:95]
    ds_read_b128 v[116:119], v3 offset:3072
    v_cvt_pk_bf16_f32 v96, v48, v49
    v_exp_f32 v52, v52
    v_exp_f32 v53, v53
    v_cvt_pk_bf16_f32 v97, v50, v51
    s_add_u32 m0, s77, 114688
    s_mov_b32 s33, 688128
    buffer_load_dwordx4 v120, s[68:71], s33 offen nt lds
    v_mfma_f32_32x32x16_bf16 v[64:79], v[104:107], v[8:11], v[32:47]
    v_exp_f32 v54, v54
    v_exp_f32 v55, v55
    v_cvt_pk_bf16_f32 v98, v52, v53
    v_exp_f32 v56, v56
    v_mfma_f32_32x32x16_bf16 v[64:79], v[108:111], v[12:15], v[64:79]
    ds_read_b128 v[104:107], v3 offset:8192
    ds_read_b128 v[108:111], v3 offset:9216
    v_cvt_pk_bf16_f32 v99, v54, v55
    v_exp_f32 v57, v57
    v_exp_f32 v58, v58
    v_exp_f32 v59, v59
    v_mfma_f32_32x32x16_bf16 v[80:95], v[112:115], v[96:99], v[80:95]
    ds_read_b128 v[112:115], v3 offset:6144
    v_cvt_pk_bf16_f32 v100, v56, v57
    v_exp_f32 v60, v60
    v_exp_f32 v61, v61
    v_cvt_pk_bf16_f32 v101, v58, v59
    v_exp_f32 v62, v62
    v_exp_f32 v63, v63
    v_cvt_pk_bf16_f32 v102, v60, v61
    s_setprio 0
    v_exp_f32 v64, v64
    v_cvt_pk_bf16_f32 v103, v62, v63
    v_exp_f32 v65, v65
    v_exp_f32 v66, v66
    s_waitcnt lgkmcnt(0)
    v_smfmac_f32_16x16x64_bf16 v[20:23], v[16:19], v[96:103], v127
    v_exp_f32 v67, v67
    v_mfma_f32_32x32x16_bf16 v[80:95], v[116:119], v[100:103], v[80:95]
    ds_read_b128 v[116:119], v3 offset:7168
    v_cvt_pk_bf16_f32 v96, v64, v65
    v_exp_f32 v68, v68
    v_exp_f32 v69, v69
    v_cvt_pk_bf16_f32 v97, v66, v67
    s_add_u32 m0, s77, 122880
    s_mov_b32 s33, 802816
    buffer_load_dwordx4 v120, s[68:71], s33 offen nt lds
    v_mfma_f32_32x32x16_bf16 v[48:63], v[104:107], v[8:11], v[32:47]
    v_exp_f32 v70, v70
    v_exp_f32 v71, v71
    v_cvt_pk_bf16_f32 v98, v68, v69
    v_exp_f32 v72, v72
    v_mfma_f32_32x32x16_bf16 v[48:63], v[108:111], v[12:15], v[48:63]
    ds_read_b128 v[104:107], v3 offset:12288
    ds_read_b128 v[108:111], v3 offset:13312
    v_cvt_pk_bf16_f32 v99, v70, v71
    v_exp_f32 v73, v73
    v_exp_f32 v74, v74
    v_exp_f32 v75, v75
    v_mfma_f32_32x32x16_bf16 v[80:95], v[112:115], v[96:99], v[80:95]
    ds_read_b128 v[112:115], v3 offset:10240
    v_cvt_pk_bf16_f32 v100, v72, v73
    v_exp_f32 v76, v76
    v_exp_f32 v77, v77
    v_cvt_pk_bf16_f32 v101, v74, v75
    buffer_load_dwordx2 v[236:237], v123, s[8:11], s97 offen offset:160
    buffer_load_dwordx2 v[238:239], v123, s[8:11], s97 offen offset:176
    s_lshr_b32 s7, s22, 2
    s_lshl_b32 s5, s7, 4
    s_lshl_b32 s6, s28, 6
    s_add_u32 s5, s5, s6
    s_lshl_b32 s5, s5, 7
    s_add_u32 s5, s5, 0x1200000
    v_and_b32 v4, 3, v0
    v_lshlrev_b32 v4, 9, v4
    buffer_load_dwordx2 v[30:31], v4, s[16:19], s5 offen sc1
    v_exp_f32 v78, v78
    v_exp_f32 v79, v79
    v_cvt_pk_bf16_f32 v102, v76, v77
    s_add_u32 s50, s50, 32768
    s_and_b32 s50, s50, 0x7ffff
    s_or_b32 s32, s50, s34
    s_add_u32 m0, s35, 131072
    s_waitcnt vmcnt(5)
    v_mfma_f32_32x32x16_bf16 v[240:255], v[232:235], v[200:203], v[240:255]
    ds_read_b32 v125, v26
    s_setprio 3
    v_exp_f32 v48, v48
    v_cvt_pk_bf16_f32 v103, v78, v79
    v_exp_f32 v49, v49
    v_exp_f32 v50, v50
    s_waitcnt lgkmcnt(0)
    v_readfirstlane_b32 s5, v125
    ds_read_b64_tr_b16 v[200:201], v25 offset:8192
    ds_read_b64_tr_b16 v[202:203], v25 offset:8704
    v_smfmac_f32_16x16x64_bf16 v[20:23], v[16:19], v[96:103], v127
    v_exp_f32 v51, v51
    v_mfma_f32_32x32x16_bf16 v[80:95], v[116:119], v[100:103], v[80:95]
    ds_read_b128 v[116:119], v3 offset:11264
    v_cvt_pk_bf16_f32 v96, v48, v49
    v_exp_f32 v52, v52
    v_exp_f32 v53, v53
    v_cvt_pk_bf16_f32 v97, v50, v51
    s_cmp_lt_u32 s5, 48
    s_cbranch_scc1 Lool_74
Lret_75:
    v_mfma_f32_32x32x16_bf16 v[64:79], v[104:107], v[8:11], v[32:47]
    v_exp_f32 v54, v54
    v_exp_f32 v55, v55
    v_cvt_pk_bf16_f32 v98, v52, v53
    v_exp_f32 v56, v56
    v_mfma_f32_32x32x16_bf16 v[64:79], v[108:111], v[12:15], v[64:79]
    ds_read_b128 v[104:107], v3 offset:32768
    ds_read_b128 v[108:111], v3 offset:33792
    v_cvt_pk_bf16_f32 v99, v54, v55
    v_exp_f32 v57, v57
    v_exp_f32 v58, v58
    v_exp_f32 v59, v59
    v_mfma_f32_32x32x16_bf16 v[80:95], v[112:115], v[96:99], v[80:95]
    ds_read_b128 v[112:115], v3 offset:14336
    v_cvt_pk_bf16_f32 v100, v56, v57
    v_exp_f32 v60, v60
    v_exp_f32 v61, v61
    v_cvt_pk_bf16_f32 v101, v58, v59
    buffer_load_dwordx4 v2, s[16:19], s32 offen offset:0 sc1 lds
    v_exp_f32 v62, v62
    v_exp_f32 v63, v63
    v_cvt_pk_bf16_f32 v102, v60, v61
    buffer_load_dwordx4 v2, s[16:19], s32 offen offset:1024 sc1 lds
    s_setprio 2
    v_exp_f32 v64, v64
    v_cvt_pk_bf16_f32 v103, v62, v63
    v_exp_f32 v65, v65
    v_exp_f32 v66, v66
    s_waitcnt lgkmcnt(0)
    buffer_load_dwordx4 v2, s[16:19], s32 offen offset:2048 sc1 lds
    v_smfmac_f32_16x16x64_bf16 v[20:23], v[16:19], v[96:103], v127
    v_exp_f32 v67, v67
    v_mfma_f32_32x32x16_bf16 v[80:95], v[116:119], v[100:103], v[80:95]
    ds_read_b128 v[116:119], v3 offset:15360
    v_cvt_pk_bf16_f32 v96, v64, v65
    v_exp_f32 v68, v68
    v_exp_f32 v69, v69
    v_cvt_pk_bf16_f32 v97, v66, v67
    ds_add_u32 v26, v27
    v_mfma_f32_32x32x16_bf16 v[48:63], v[104:107], v[8:11], v[32:47]
    v_exp_f32 v70, v70
    v_exp_f32 v71, v71
    v_cvt_pk_bf16_f32 v98, v68, v69
    v_exp_f32 v72, v72
    v_mfma_f32_32x32x16_bf16 v[48:63], v[108:111], v[12:15], v[48:63]
    ds_read_b128 v[104:107], v3 offset:36864
    ds_read_b128 v[108:111], v3 offset:37888
    v_cvt_pk_bf16_f32 v99, v70, v71
    v_exp_f32 v73, v73
    v_exp_f32 v74, v74
    v_exp_f32 v75, v75
    v_mfma_f32_32x32x16_bf16 v[80:95], v[112:115], v[96:99], v[80:95]
    ds_read_b128 v[112:115], v3 offset:34816
    v_cvt_pk_bf16_f32 v100, v72, v73
    v_exp_f32 v76, v76
    v_exp_f32 v77, v77
    v_cvt_pk_bf16_f32 v101, v74, v75
    buffer_load_dwordx4 v2, s[16:19], s32 offen offset:3072 sc1 lds
    buffer_load_dwordx2 v[232:233], v123, s[8:11], s97 offen offset:192
    buffer_load_dwordx2 v[234:235], v123, s[8:11], s97 offen offset:208
    v_exp_f32 v78, v78
    v_exp_f32 v79, v79
    v_cvt_pk_bf16_f32 v102, v76, v77
    s_waitcnt vmcnt(7)
    v_mfma_f32_32x32x16_bf16 v[240:255], v[236:239], v[200:203], v[240:255]
    s_setprio 1
    v_exp_f32 v48, v48
    v_cvt_pk_bf16_f32 v103, v78, v79
    v_exp_f32 v49, v49
    v_exp_f32 v50, v50
    s_waitcnt lgkmcnt(0)
    ds_read_b64_tr_b16 v[200:201], v25 offset:16384
    ds_read_b64_tr_b16 v[202:203], v25 offset:16896
    v_smfmac_f32_16x16x64_bf16 v[20:23], v[16:19], v[96:103], v127
    v_exp_f32 v51, v51
    v_mfma_f32_32x32x16_bf16 v[80:95], v[116:119], v[100:103], v[80:95]
    ds_read_b128 v[116:119], v3 offset:35840
    v_cvt_pk_bf16_f32 v96, v48, v49
    v_exp_f32 v52, v52
    v_exp_f32 v53, v53
    v_cvt_pk_bf16_f32 v97, v50, v51
    s_add_u32 m0, s77, 106496
    s_add_u32 s33, s46, 0
    buffer_load_dwordx4 v28, s[52:55], s33 offen nt lds
    v_mfma_f32_32x32x16_bf16 v[64:79], v[104:107], v[8:11], v[32:47]
    v_exp_f32 v54, v54
    v_exp_f32 v55, v55
    v_cvt_pk_bf16_f32 v98, v52, v53
    v_exp_f32 v56, v56
    v_mfma_f32_32x32x16_bf16 v[64:79], v[108:111], v[12:15], v[64:79]
    ds_read_b128 v[104:107], v3 offset:40960
    ds_read_b128 v[108:111], v3 offset:41984
    v_cvt_pk_bf16_f32 v99, v54, v55
    v_exp_f32 v57, v57
    v_exp_f32 v58, v58
    v_exp_f32 v59, v59
    v_mfma_f32_32x32x16_bf16 v[80:95], v[112:115], v[96:99], v[80:95]
    ds_read_b128 v[112:115], v3 offset:38912
    v_cvt_pk_bf16_f32 v100, v56, v57
    v_exp_f32 v60, v60
    v_exp_f32 v61, v61
    v_cvt_pk_bf16_f32 v101, v58, v59
    s_xor_b32 s5, s25, 1
    s_waitcnt vmcnt(7)
    v_subrev_u32 v31, s88, v31
    v_add_u32 v31, 0x100000, v31
    v_cmp_eq_u32 vcc, s5, v30
    v_min_u32 v31, 0x1fffff, v31
    v_and_b32 v4, 3, v0
    v_cndmask_b32 v31, -1, v31, vcc
    v_lshl_or_b32 v31, v31, 2, v4
    v_exp_f32 v62, v62
    v_exp_f32 v63, v63
    v_cvt_pk_bf16_f32 v102, v60, v61
    v_readlane_b32 s88, v31, 0
    v_readlane_b32 s89, v31, 1
    v_readlane_b32 s90, v31, 2
    v_readlane_b32 s91, v31, 3
    s_setprio 0
    v_exp_f32 v64, v64
    v_cvt_pk_bf16_f32 v103, v62, v63
    v_exp_f32 v65, v65
    v_exp_f32 v66, v66
    s_waitcnt lgkmcnt(0)
    s_min_u32 s5, s88, s89
    s_max_u32 s89, s88, s89
    s_mov_b32 s88, s5
    s_min_u32 s5, s90, s91
    s_max_u32 s91, s90, s91
    s_mov_b32 s90, s5
    v_smfmac_f32_16x16x64_bf16 v[20:23], v[16:19], v[96:103], v127
    v_exp_f32 v67, v67
    v_mfma_f32_32x32x16_bf16 v[80:95], v[116:119], v[100:103], v[80:95]
    ds_read_b128 v[116:119], v3 offset:39936
    v_cvt_pk_bf16_f32 v96, v64, v65
    v_exp_f32 v68, v68
    v_exp_f32 v69, v69
    v_cvt_pk_bf16_f32 v97, v66, v67
    s_add_u32 m0, s77, 114688
    s_add_u32 s33, s46, 32768
    buffer_load_dwordx4 v28, s[52:55], s33 offen nt lds
    v_mfma_f32_32x32x16_bf16 v[48:63], v[104:107], v[8:11], v[32:47]
    v_exp_f32 v70, v70
    v_exp_f32 v71, v71
    v_cvt_pk_bf16_f32 v98, v68, v69
    v_exp_f32 v72, v72
    v_mfma_f32_32x32x16_bf16 v[48:63], v[108:111], v[12:15], v[48:63]
    ds_read_b128 v[104:107], v3 offset:45056
    ds_read_b128 v[108:111], v3 offset:46080
    v_cvt_pk_bf16_f32 v99, v70, v71
    v_exp_f32 v73, v73
    v_exp_f32 v74, v74
    v_exp_f32 v75, v75
    v_mfma_f32_32x32x16_bf16 v[80:95], v[112:115], v[96:99], v[80:95]
    ds_read_b128 v[112:115], v3 offset:43008
    v_cvt_pk_bf16_f32 v100, v72, v73
    v_exp_f32 v76, v76
    v_exp_f32 v77, v77
    v_cvt_pk_bf16_f32 v101, v74, v75
    buffer_load_dwordx2 v[236:237], v123, s[8:11], s97 offen offset:224
    buffer_load_dwordx2 v[238:239], v123, s[8:11], s97 offen offset:240
    s_min_u32 s5, s88, s90
    s_max_u32 s90, s88, s90
    s_mov_b32 s88, s5
    s_min_u32 s5, s89, s91
    s_max_u32 s91, s89, s91
    s_mov_b32 s89, s5
    v_exp_f32 v78, v78
    v_exp_f32 v79, v79
    v_cvt_pk_bf16_f32 v102, v76, v77
    s_add_u32 s50, s50, 32768
    s_and_b32 s50, s50, 0x7ffff
    s_or_b32 s32, s50, s34
    s_add_u32 m0, s35, 0
    s_waitcnt vmcnt(4)
    v_mfma_f32_32x32x16_bf16 v[240:255], v[232:235], v[200:203], v[240:255]
    s_min_u32 s5, s89, s90
    s_max_u32 s90, s89, s90
    s_mov_b32 s89, s5
    s_and_b32 s85, s88, 3
    s_and_b32 s5, s89, 3
    s_lshl_b32 s5, s5, 2
    s_or_b32 s85, s85, s5
    ds_read_b32 v125, v26
    s_setprio 3
    v_exp_f32 v48, v48
    v_cvt_pk_bf16_f32 v103, v78, v79
    v_exp_f32 v49, v49
    v_exp_f32 v50, v50
    s_waitcnt lgkmcnt(0)
    v_readfirstlane_b32 s5, v125
    ds_read_b64_tr_b16 v[200:201], v25 offset:24576
    ds_read_b64_tr_b16 v[202:203], v25 offset:25088
    v_smfmac_f32_16x16x64_bf16 v[20:23], v[16:19], v[96:103], v127
    v_exp_f32 v51, v51
    v_mfma_f32_32x32x16_bf16 v[80:95], v[116:119], v[100:103], v[80:95]
    ds_read_b128 v[116:119], v3 offset:44032
    v_cvt_pk_bf16_f32 v96, v48, v49
    v_exp_f32 v52, v52
    v_exp_f32 v53, v53
    v_cvt_pk_bf16_f32 v97, v50, v51
    s_cmp_lt_u32 s5, 56
    s_cbranch_scc1 Lool_78
Lret_79:
    v_and_b32 v31, 31, v0
    v_lshlrev_b32 v31, 2, v31
    s_lshl_b32 s83, s47, 2
    s_add_u32 s83, s83, 0x100d000
    buffer_load_dword v30, v31, s[16:19], s83 offen sc1
    v_mfma_f32_32x32x16_bf16 v[64:79], v[104:107], v[8:11], v[32:47]
    v_exp_f32 v54, v54
    v_exp_f32 v55, v55
    v_cvt_pk_bf16_f32 v98, v52, v53
    v_exp_f32 v56, v56
    v_mfma_f32_32x32x16_bf16 v[64:79], v[108:111], v[12:15], v[64:79]
    ds_read_b128 v[104:107], v6 offset:0
    ds_read_b128 v[108:111], v6 offset:1024
    v_cvt_pk_bf16_f32 v99, v54, v55
    v_exp_f32 v57, v57
    v_exp_f32 v58, v58
    v_exp_f32 v59, v59
    v_mfma_f32_32x32x16_bf16 v[80:95], v[112:115], v[96:99], v[80:95]
    ds_read_b128 v[112:115], v3 offset:47104
    v_cvt_pk_bf16_f32 v100, v56, v57
    v_exp_f32 v60, v60
    v_exp_f32 v61, v61
    v_cvt_pk_bf16_f32 v101, v58, v59
    buffer_load_dwordx4 v2, s[16:19], s32 offen offset:0 sc1 lds
    s_and_b32 s5, s90, 3
    s_lshl_b32 s5, s5, 4
    s_or_b32 s85, s85, s5
    s_and_b32 s5, s91, 3
    s_lshl_b32 s5, s5, 6
    s_or_b32 s85, s85, s5
    v_exp_f32 v62, v62
    v_exp_f32 v63, v63
    v_cvt_pk_bf16_f32 v102, v60, v61
    buffer_load_dwordx4 v2, s[16:19], s32 offen offset:1024 sc1 lds
    s_lshl_b32 s5, s22, 2
    s_add_u32 s5, s5, 98624
    v_mov_b32 v4, s5
    v_mov_b32 v5, s85
    ds_write_b32 v4, v5
    s_setprio 2
    v_exp_f32 v64, v64
    v_cvt_pk_bf16_f32 v103, v62, v63
    v_exp_f32 v65, v65
    v_exp_f32 v66, v66
    s_waitcnt lgkmcnt(0)
    buffer_load_dwordx4 v2, s[16:19], s32 offen offset:2048 sc1 lds
    v_smfmac_f32_16x16x64_bf16 v[20:23], v[16:19], v[96:103], v127
    v_exp_f32 v67, v67
    v_mfma_f32_32x32x16_bf16 v[80:95], v[116:119], v[100:103], v[80:95]
    ds_read_b128 v[116:119], v3 offset:48128
    v_cvt_pk_bf16_f32 v96, v64, v65
    v_exp_f32 v68, v68
    v_exp_f32 v69, v69
    v_cvt_pk_bf16_f32 v97, v66, v67
    ds_add_u32 v26, v27
    v_mfma_f32_32x32x16_bf16 v[48:63], v[104:107], v[8:11], v[32:47]
    v_exp_f32 v70, v70
    v_exp_f32 v71, v71
    v_cvt_pk_bf16_f32 v98, v68, v69
    v_exp_f32 v72, v72
    v_mfma_f32_32x32x16_bf16 v[48:63], v[108:111], v[12:15], v[48:63]
    ds_read_b128 v[104:107], v6 offset:4096
    ds_read_b128 v[108:111], v6 offset:5120
    v_cvt_pk_bf16_f32 v99, v70, v71
    v_exp_f32 v73, v73
    v_exp_f32 v74, v74
    v_exp_f32 v75, v75
    v_mfma_f32_32x32x16_bf16 v[80:95], v[112:115], v[96:99], v[80:95]
    ds_read_b128 v[112:115], v6 offset:2048
    v_cvt_pk_bf16_f32 v100, v72, v73
    v_exp_f32 v76, v76
    v_exp_f32 v77, v77
    v_cvt_pk_bf16_f32 v101, v74, v75
    buffer_load_dwordx4 v2, s[16:19], s32 offen offset:3072 sc1 lds
    v_exp_f32 v78, v78
    v_exp_f32 v79, v79
    v_cvt_pk_bf16_f32 v102, v76, v77
    s_waitcnt vmcnt(5)
    v_mfma_f32_32x32x16_bf16 v[240:255], v[236:239], v[200:203], v[240:255]
    s_setprio 1
    v_exp_f32 v48, v48
    v_cvt_pk_bf16_f32 v103, v78, v79
    v_exp_f32 v49, v49
    v_exp_f32 v50, v50
    s_waitcnt lgkmcnt(0)
    ds_read_b64_tr_b16 v[208:209], v25 offset:8192
    ds_read_b64_tr_b16 v[210:211], v25 offset:8704
    v_smfmac_f32_16x16x64_bf16 v[20:23], v[16:19], v[96:103], v127
    v_exp_f32 v51, v51
    v_mfma_f32_32x32x16_bf16 v[80:95], v[116:119], v[100:103], v[80:95]
    ds_read_b128 v[116:119], v6 offset:3072
    v_cvt_pk_bf16_f32 v96, v48, v49
    v_exp_f32 v52, v52
    v_exp_f32 v53, v53
    v_cvt_pk_bf16_f32 v97, v50, v51
    s_add_u32 m0, s77, 122880
    s_add_u32 s33, s46, 65536
    buffer_load_dwordx4 v28, s[52:55], s33 offen nt lds
    v_mfma_f32_32x32x16_bf16 v[64:79], v[104:107], v[8:11], v[32:47]
    v_exp_f32 v54, v54
    v_exp_f32 v55, v55
    v_cvt_pk_bf16_f32 v98, v52, v53
    v_exp_f32 v56, v56
    v_mfma_f32_32x32x16_bf16 v[64:79], v[108:111], v[12:15], v[64:79]
    ds_read_b128 v[104:107], v6 offset:8192
    ds_read_b128 v[108:111], v6 offset:9216
    v_cvt_pk_bf16_f32 v99, v54, v55
    v_exp_f32 v57, v57
    v_exp_f32 v58, v58
    v_exp_f32 v59, v59
    v_mfma_f32_32x32x16_bf16 v[80:95], v[112:115], v[96:99], v[80:95]
    ds_read_b128 v[112:115], v6 offset:6144
    v_cvt_pk_bf16_f32 v100, v56, v57
    v_exp_f32 v60, v60
    v_exp_f32 v61, v61
    v_cvt_pk_bf16_f32 v101, v58, v59
    v_exp_f32 v62, v62
    v_exp_f32 v63, v63
    v_cvt_pk_bf16_f32 v102, v60, v61
    v_lshlrev_b32 v4, 3, v0
    v_mov_b32_dpp v242, v240 quad_perm:[1,1,3,3] row_mask:0xf bank_mask:0xf
    v_mov_b32 v241, s25
    v_mov_b32 v243, s25
    s_mov_b64 exec, 0x55555555
    buffer_store_dwordx4 v[240:243], v4, s[16:19], s44 offen sc1
    s_mov_b64 exec, -1
    s_setprio 0
    v_exp_f32 v64, v64
    v_cvt_pk_bf16_f32 v103, v62, v63
    v_exp_f32 v65, v65
    v_exp_f32 v66, v66
    s_waitcnt lgkmcnt(0)
    s_waitcnt vmcnt(6)
    v_cmp_ne_u32 vcc, s25, v30
    ds_read_b64_tr_b16 v[212:213], v25 offset:16384
    ds_read_b64_tr_b16 v[214:215], v25 offset:16896
    v_smfmac_f32_16x16x64_bf16 v[20:23], v[16:19], v[96:103], v127
    v_exp_f32 v67, v67
    v_mfma_f32_32x32x16_bf16 v[80:95], v[116:119], v[100:103], v[80:95]
    ds_read_b128 v[116:119], v6 offset:7168
    v_cvt_pk_bf16_f32 v96, v64, v65
    v_exp_f32 v68, v68
    v_exp_f32 v69, v69
    v_cvt_pk_bf16_f32 v97, v66, v67
    s_cmp_lg_u64 vcc, 0
    s_cbranch_scc1 Lool_82
Lret_83:
    s_lshl_b32 s82, s47, 10
    s_add_u32 s82, s82, 0x1600000
    s_add_u32 m0, s77, 106496
    s_add_u32 s33, s46, 98304
    buffer_load_dwordx4 v28, s[52:55], s33 offen nt lds
    v_mfma_f32_32x32x16_bf16 v[48:63], v[104:107], v[8:11], v[32:47]
    v_exp_f32 v70, v70
    v_exp_f32 v71, v71
    v_cvt_pk_bf16_f32 v98, v68, v69
    v_exp_f32 v72, v72
    v_mfma_f32_32x32x16_bf16 v[48:63], v[108:111], v[12:15], v[48:63]
    ds_read_b128 v[104:107], v6 offset:12288
    ds_read_b128 v[108:111], v6 offset:13312
    v_cvt_pk_bf16_f32 v99, v70, v71
    v_exp_f32 v73, v73
    v_exp_f32 v74, v74
    v_exp_f32 v75, v75
    v_mfma_f32_32x32x16_bf16 v[80:95], v[112:115], v[96:99], v[80:95]
    ds_read_b128 v[112:115], v6 offset:10240
    v_cvt_pk_bf16_f32 v100, v72, v73
    v_exp_f32 v76, v76
    v_exp_f32 v77, v77
    v_cvt_pk_bf16_f32 v101, v74, v75
    v_exp_f32 v78, v78
    v_exp_f32 v79, v79
    v_cvt_pk_bf16_f32 v102, v76, v77
    s_add_u32 s50, s50, 32768
    s_and_b32 s50, s50, 0x7ffff
    s_or_b32 s32, s50, s34
    s_add_u32 m0, s35, 32768
    ds_read_b32 v125, v26
    s_setprio 3
    v_exp_f32 v48, v48
    v_cvt_pk_bf16_f32 v103, v78, v79
    v_exp_f32 v49, v49
    v_exp_f32 v50, v50
    s_waitcnt lgkmcnt(0)
    v_readfirstlane_b32 s5, v125
    v_smfmac_f32_16x16x64_bf16 v[20:23], v[16:19], v[96:103], v127
    v_exp_f32 v51, v51
    v_mfma_f32_32x32x16_bf16 v[80:95], v[116:119], v[100:103], v[80:95]
    ds_read_b128 v[116:119], v6 offset:11264
    v_cvt_pk_bf16_f32 v96, v48, v49
    v_exp_f32 v52, v52
    v_exp_f32 v53, v53
    v_cvt_pk_bf16_f32 v97, v50, v51
    s_cmp_lt_u32 s5, 64
    s_cbranch_scc1 Lool_86
Lret_87:
    v_mfma_f32_32x32x16_bf16 v[64:79], v[104:107], v[8:11], v[32:47]
    v_exp_f32 v54, v54
    v_exp_f32 v55, v55
    v_cvt_pk_bf16_f32 v98, v52, v53
    v_exp_f32 v56, v56
    v_mfma_f32_32x32x16_bf16 v[64:79], v[108:111], v[12:15], v[64:79]
    ds_read_b128 v[104:107], v7 offset:0
    ds_read_b128 v[108:111], v7 offset:1024
    v_cvt_pk_bf16_f32 v99, v54, v55
    v_exp_f32 v57, v57
    v_exp_f32 v58, v58
    v_exp_f32 v59, v59
    v_mfma_f32_32x32x16_bf16 v[80:95], v[112:115], v[96:99], v[80:95]
    ds_read_b128 v[112:115], v6 offset:14336
    v_cvt_pk_bf16_f32 v100, v56, v57
    v_exp_f32 v60, v60
    v_exp_f32 v61, v61
    v_cvt_pk_bf16_f32 v101, v58, v59
    buffer_load_dwordx4 v2, s[16:19], s32 offen offset:0 sc1 lds
    v_exp_f32 v62, v62
    v_exp_f32 v63, v63
    v_cvt_pk_bf16_f32 v102, v60, v61
    buffer_load_dwordx4 v2, s[16:19], s32 offen offset:1024 sc1 lds
    s_and_b32 s5, s22, 4
    s_lshl_b32 s5, s5, 2
    s_add_u32 s5, s5, 98624
    v_mov_b32 v4, s5
    ds_read_b32 v5, v4
    s_setprio 2
    v_exp_f32 v64, v64
    v_cvt_pk_bf16_f32 v103, v62, v63
    v_exp_f32 v65, v65
    v_exp_f32 v66, v66
    s_waitcnt lgkmcnt(0)
    buffer_load_dwordx4 v2, s[16:19], s32 offen offset:2048 sc1 lds
    v_readfirstlane_b32 s85, v5
    v_xor_b32 v4, 16, v4
    ds_read_b32 v5, v4
    v_smfmac_f32_16x16x64_bf16 v[20:23], v[16:19], v[96:103], v127
    v_exp_f32 v67, v67
    v_mfma_f32_32x32x16_bf16 v[80:95], v[116:119], v[100:103], v[80:95]
    ds_read_b128 v[116:119], v6 offset:15360
    v_cvt_pk_bf16_f32 v96, v64, v65
    v_exp_f32 v68, v68
    v_exp_f32 v69, v69
    v_cvt_pk_bf16_f32 v97, v66, v67
    s_waitcnt vmcnt(6)
    ds_add_u32 v26, v27
    v_mfma_f32_32x32x16_bf16 v[48:63], v[104:107], v[8:11], v[32:47]
    v_exp_f32 v70, v70
    v_exp_f32 v71, v71
    v_cvt_pk_bf16_f32 v98, v68, v69
    v_exp_f32 v72, v72
    v_mfma_f32_32x32x16_bf16 v[48:63], v[108:111], v[12:15], v[48:63]
    ds_read_b128 v[104:107], v7 offset:4096
    ds_read_b128 v[108:111], v7 offset:5120
    v_cvt_pk_bf16_f32 v99, v70, v71
    v_exp_f32 v73, v73
    v_exp_f32 v74, v74
    v_exp_f32 v75, v75
    v_mfma_f32_32x32x16_bf16 v[80:95], v[112:115], v[96:99], v[80:95]
    ds_read_b128 v[112:115], v7 offset:2048
    v_cvt_pk_bf16_f32 v100, v72, v73
    v_exp_f32 v76, v76
    v_exp_f32 v77, v77
    v_cvt_pk_bf16_f32 v101, v74, v75
    buffer_load_dwordx4 v2, s[16:19], s32 offen offset:3072 sc1 lds
    v_exp_f32 v78, v78
    v_exp_f32 v79, v79
    v_cvt_pk_bf16_f32 v102, v76, v77
    s_setprio 1
    v_exp_f32 v48, v48
    v_cvt_pk_bf16_f32 v103, v78, v79
    v_exp_f32 v49, v49
    v_exp_f32 v50, v50
    s_waitcnt lgkmcnt(0)
    s_waitcnt vmcnt(6)
    ds_read_b64_tr_b16 v[216:217], v25 offset:24576
    ds_read_b64_tr_b16 v[218:219], v25 offset:25088
    v_readfirstlane_b32 s91, v5
    v_smfmac_f32_16x16x64_bf16 v[20:23], v[16:19], v[96:103], v127
    v_exp_f32 v51, v51
    v_mfma_f32_32x32x16_bf16 v[80:95], v[116:119], v[100:103], v[80:95]
    ds_read_b128 v[116:119], v7 offset:3072
    v_cvt_pk_bf16_f32 v96, v48, v49
    v_exp_f32 v52, v52
    v_exp_f32 v53, v53
    v_cvt_pk_bf16_f32 v97, v50, v51
    v_mfma_f32_32x32x16_bf16 v[64:79], v[104:107], v[8:11], v[32:47]
    v_exp_f32 v54, v54
    v_exp_f32 v55, v55
    v_cvt_pk_bf16_f32 v98, v52, v53
    v_exp_f32 v56, v56
    v_mfma_f32_32x32x16_bf16 v[64:79], v[108:111], v[12:15], v[64:79]
    ds_read_b128 v[104:107], v7 offset:8192
    ds_read_b128 v[108:111], v7 offset:9216
    v_cvt_pk_bf16_f32 v99, v54, v55
    v_exp_f32 v57, v57
    v_exp_f32 v58, v58
    v_exp_f32 v59, v59
    v_mfma_f32_32x32x16_bf16 v[80:95], v[112:115], v[96:99], v[80:95]
    ds_read_b128 v[112:115], v7 offset:6144
    v_cvt_pk_bf16_f32 v100, v56, v57
    v_exp_f32 v60, v60
    v_exp_f32 v61, v61
    v_cvt_pk_bf16_f32 v101, v58, v59
    v_exp_f32 v62, v62
    v_exp_f32 v63, v63
    v_cvt_pk_bf16_f32 v102, v60, v61
    s_bfe_u32 s5, s85, 0x20000
    s_lshl_b32 s5, s5, 13
    s_add_u32 s79, s82, s5
    buffer_load_dwordx4 v[128:131], v1, s[16:19], s79 offen offset:0 sc1
    s_setprio 0
    v_exp_f32 v64, v64
    v_cvt_pk_bf16_f32 v103, v62, v63
    v_exp_f32 v65, v65
    v_exp_f32 v66, v66
    s_waitcnt lgkmcnt(0)
    s_waitcnt vmcnt(5)
    ds_read_b64_tr_b16 v[220:221], v25 offset:8192
    ds_read_b64_tr_b16 v[222:223], v25 offset:8704
    v_smfmac_f32_16x16x64_bf16 v[20:23], v[16:19], v[96:103], v127
    v_exp_f32 v67, v67
    v_mfma_f32_32x32x16_bf16 v[80:95], v[116:119], v[100:103], v[80:95]
    ds_read_b128 v[116:119], v7 offset:7168
    v_cvt_pk_bf16_f32 v96, v64, v65
    v_exp_f32 v68, v68
    v_exp_f32 v69, v69
    v_cvt_pk_bf16_f32 v97, v66, v67
    v_mfma_f32_32x32x16_bf16 v[48:63], v[104:107], v[8:11], v[32:47]
    v_exp_f32 v70, v70
    v_exp_f32 v71, v71
    v_cvt_pk_bf16_f32 v98, v68, v69
    v_exp_f32 v72, v72
    v_mfma_f32_32x32x16_bf16 v[48:63], v[108:111], v[12:15], v[48:63]
    ds_read_b128 v[104:107], v7 offset:12288
    ds_read_b128 v[108:111], v7 offset:13312
    v_cvt_pk_bf16_f32 v99, v70, v71
    v_exp_f32 v73, v73
    v_exp_f32 v74, v74
    v_exp_f32 v75, v75
    v_mfma_f32_32x32x16_bf16 v[80:95], v[112:115], v[96:99], v[80:95]
    ds_read_b128 v[112:115], v7 offset:10240
    v_cvt_pk_bf16_f32 v100, v72, v73
    v_exp_f32 v76, v76
    v_exp_f32 v77, v77
    v_cvt_pk_bf16_f32 v101, v74, v75
    v_exp_f32 v78, v78
    v_exp_f32 v79, v79
    v_cvt_pk_bf16_f32 v102, v76, v77
    s_add_u32 s50, s50, 32768
    s_and_b32 s50, s50, 0x7ffff
    s_or_b32 s32, s50, s34
    s_add_u32 m0, s35, 65536
    buffer_load_dwordx4 v[132:135], v1, s[16:19], s79 offen offset:1024 sc1
    ds_read_b32 v125, v26
    s_setprio 3
    v_exp_f32 v48, v48
    v_cvt_pk_bf16_f32 v103, v78, v79
    v_exp_f32 v49, v49
    v_exp_f32 v50, v50
    s_waitcnt lgkmcnt(0)
    v_readfirstlane_b32 s5, v125
    v_smfmac_f32_16x16x64_bf16 v[20:23], v[16:19], v[96:103], v127
    v_exp_f32 v51, v51
    v_mfma_f32_32x32x16_bf16 v[80:95], v[116:119], v[100:103], v[80:95]
    ds_read_b128 v[116:119], v7 offset:11264
    v_cvt_pk_bf16_f32 v96, v48, v49
    v_exp_f32 v52, v52
    v_exp_f32 v53, v53
    v_cvt_pk_bf16_f32 v97, v50, v51
    s_cmp_lt_u32 s5, 72
    s_cbranch_scc1 Lool_90
Lret_91:
    v_mfma_f32_32x32x16_bf16 v[64:79], v[104:107], v[8:11], v[32:47]
    v_exp_f32 v54, v54
    v_exp_f32 v55, v55
    v_cvt_pk_bf16_f32 v98, v52, v53
    v_exp_f32 v56, v56
    v_mfma_f32_32x32x16_bf16 v[64:79], v[108:111], v[12:15], v[64:79]
    ds_read_b128 v[104:107], v3 offset:0
    ds_read_b128 v[108:111], v3 offset:1024
    v_cvt_pk_bf16_f32 v99, v54, v55
    v_exp_f32 v57, v57
    v_exp_f32 v58, v58
    v_exp_f32 v59, v59
    v_mfma_f32_32x32x16_bf16 v[80:95], v[112:115], v[96:99], v[80:95]
    ds_read_b128 v[112:115], v7 offset:14336
    v_cvt_pk_bf16_f32 v100, v56, v57
    v_exp_f32 v60, v60
    v_exp_f32 v61, v61
    v_cvt_pk_bf16_f32 v101, v58, v59
    buffer_load_dwordx4 v2, s[16:19], s32 offen offset:0 sc1 lds
    v_exp_f32 v62, v62
    v_exp_f32 v63, v63
    v_cvt_pk_bf16_f32 v102, v60, v61
    buffer_load_dwordx4 v2, s[16:19], s32 offen offset:1024 sc1 lds
    buffer_load_dwordx4 v[136:139], v1, s[16:19], s79 offen offset:2048 sc1
    s_setprio 2
    v_exp_f32 v64, v64
    v_cvt_pk_bf16_f32 v103, v62, v63
    v_exp_f32 v65, v65
    v_exp_f32 v66, v66
    s_waitcnt lgkmcnt(0)
    buffer_load_dwordx4 v2, s[16:19], s32 offen offset:2048 sc1 lds
    v_smfmac_f32_16x16x64_bf16 v[20:23], v[16:19], v[96:103], v127
    v_exp_f32 v67, v67
    v_mfma_f32_32x32x16_bf16 v[80:95], v[116:119], v[100:103], v[80:95]
    ds_read_b128 v[116:119], v7 offset:15360
    v_cvt_pk_bf16_f32 v96, v64, v65
    v_exp_f32 v68, v68
    v_exp_f32 v69, v69
    v_cvt_pk_bf16_f32 v97, v66, v67
    s_waitcnt vmcnt(6)
    ds_add_u32 v26, v27
    v_mfma_f32_32x32x16_bf16 v[48:63], v[104:107], v[8:11], v[32:47]
    v_exp_f32 v70, v70
    v_exp_f32 v71, v71
    v_cvt_pk_bf16_f32 v98, v68, v69
    v_exp_f32 v72, v72
    v_mfma_f32_32x32x16_bf16 v[48:63], v[108:111], v[12:15], v[48:63]
    ds_read_b128 v[104:107], v3 offset:4096
    ds_read_b128 v[108:111], v3 offset:5120
    v_cvt_pk_bf16_f32 v99, v70, v71
    v_exp_f32 v73, v73
    v_exp_f32 v74, v74
    v_exp_f32 v75, v75
    v_mfma_f32_32x32x16_bf16 v[80:95], v[112:115], v[96:99], v[80:95]
    ds_read_b128 v[112:115], v3 offset:2048
    v_cvt_pk_bf16_f32 v100, v72, v73
    v_exp_f32 v76, v76
    v_exp_f32 v77, v77
    v_cvt_pk_bf16_f32 v101, v74, v75
    buffer_load_dwordx4 v2, s[16:19], s32 offen offset:3072 sc1 lds
    v_exp_f32 v78, v78
    v_exp_f32 v79, v79
    v_cvt_pk_bf16_f32 v102, v76, v77
    buffer_load_dwordx4 v[140:143], v1, s[16:19], s79 offen offset:3072 sc1
    s_setprio 1
    v_exp_f32 v48, v48
    v_cvt_pk_bf16_f32 v103, v78, v79
    v_exp_f32 v49, v49
    v_exp_f32 v50, v50
    s_waitcnt lgkmcnt(0)
    v_smfmac_f32_16x16x64_bf16 v[20:23], v[16:19], v[96:103], v127
    v_exp_f32 v51, v51
    v_mfma_f32_32x32x16_bf16 v[80:95], v[116:119], v[100:103], v[80:95]
    ds_read_b128 v[116:119], v3 offset:3072
    v_cvt_pk_bf16_f32 v96, v48, v49
    v_exp_f32 v52, v52
    v_exp_f32 v53, v53
    v_cvt_pk_bf16_f32 v97, v50, v51
    v_mfma_f32_32x32x16_bf16 v[64:79], v[104:107], v[8:11], v[32:47]
    v_exp_f32 v54, v54
    v_exp_f32 v55, v55
    v_cvt_pk_bf16_f32 v98, v52, v53
    v_exp_f32 v56, v56
    v_mfma_f32_32x32x16_bf16 v[64:79], v[108:111], v[12:15], v[64:79]
    ds_read_b128 v[104:107], v3 offset:8192
    ds_read_b128 v[108:111], v3 offset:9216
    v_cvt_pk_bf16_f32 v99, v54, v55
    v_exp_f32 v57, v57
    v_exp_f32 v58, v58
    v_exp_f32 v59, v59
    v_mfma_f32_32x32x16_bf16 v[80:95], v[112:115], v[96:99], v[80:95]
    ds_read_b128 v[112:115], v3 offset:6144
    v_cvt_pk_bf16_f32 v100, v56, v57
    v_exp_f32 v60, v60
    v_exp_f32 v61, v61
    v_cvt_pk_bf16_f32 v101, v58, v59
    v_exp_f32 v62, v62
    v_exp_f32 v63, v63
    v_cvt_pk_bf16_f32 v102, v60, v61
    s_add_u32 s79, s79, 4096
    buffer_load_dwordx4 v[144:147], v1, s[16:19], s79 offen offset:0 sc1
    s_setprio 0
    v_exp_f32 v64, v64
    v_cvt_pk_bf16_f32 v103, v62, v63
    v_exp_f32 v65, v65
    v_exp_f32 v66, v66
    s_waitcnt lgkmcnt(0)
    v_smfmac_f32_16x16x64_bf16 v[20:23], v[16:19], v[96:103], v127
    v_exp_f32 v67, v67
    v_mfma_f32_32x32x16_bf16 v[80:95], v[116:119], v[100:103], v[80:95]
    ds_read_b128 v[116:119], v3 offset:7168
    v_cvt_pk_bf16_f32 v96, v64, v65
    v_exp_f32 v68, v68
    v_exp_f32 v69, v69
    v_cvt_pk_bf16_f32 v97, v66, v67
    v_mfma_f32_32x32x16_bf16 v[48:63], v[104:107], v[8:11], v[32:47]
    v_exp_f32 v70, v70
    v_exp_f32 v71, v71
    v_cvt_pk_bf16_f32 v98, v68, v69
    v_exp_f32 v72, v72
    v_mfma_f32_32x32x16_bf16 v[48:63], v[108:111], v[12:15], v[48:63]
    ds_read_b128 v[104:107], v3 offset:12288
    ds_read_b128 v[108:111], v3 offset:13312
    v_cvt_pk_bf16_f32 v99, v70, v71
    v_exp_f32 v73, v73
    v_exp_f32 v74, v74
    v_exp_f32 v75, v75
    v_mfma_f32_32x32x16_bf16 v[80:95], v[112:115], v[96:99], v[80:95]
    ds_read_b128 v[112:115], v3 offset:10240
    v_cvt_pk_bf16_f32 v100, v72, v73
    v_exp_f32 v76, v76
    v_exp_f32 v77, v77
    v_cvt_pk_bf16_f32 v101, v74, v75
    v_exp_f32 v78, v78
    v_exp_f32 v79, v79
    v_cvt_pk_bf16_f32 v102, v76, v77
    s_add_u32 s50, s50, 32768
    s_and_b32 s50, s50, 0x7ffff
    s_or_b32 s32, s50, s34
    buffer_load_dwordx4 v[148:151], v1, s[16:19], s79 offen offset:1024 sc1
    ds_read_b32 v125, v26
    s_setprio 3
    v_exp_f32 v48, v48
    v_cvt_pk_bf16_f32 v103, v78, v79
    v_exp_f32 v49, v49
    v_exp_f32 v50, v50
    s_waitcnt lgkmcnt(0)
    v_readfirstlane_b32 s5, v125
    v_smfmac_f32_16x16x64_bf16 v[20:23], v[16:19], v[96:103], v127
    v_exp_f32 v51, v51
    v_mfma_f32_32x32x16_bf16 v[80:95], v[116:119], v[100:103], v[80:95]
    ds_read_b128 v[116:119], v3 offset:11264
    v_cvt_pk_bf16_f32 v96, v48, v49
    v_exp_f32 v52, v52
    v_exp_f32 v53, v53
    v_cvt_pk_bf16_f32 v97, v50, v51
    s_cmp_lt_u32 s5, 80
    s_cbranch_scc1 Lool_94
Lret_95:
    s_lshl_b32 s6, s77, 1
    s_add_u32 m0, s6, 106496
    s_add_u32 s7, s48, 27648
    buffer_load_dwordx4 v1, s[16:19], s48 offen sc1 lds
    buffer_load_dwordx4 v1, s[16:19], s7 offen offset:1024 sc1 lds
    v_mfma_f32_32x32x16_bf16 v[64:79], v[104:107], v[8:11], v[32:47]
    v_exp_f32 v54, v54
    v_exp_f32 v55, v55
    v_cvt_pk_bf16_f32 v98, v52, v53
    v_exp_f32 v56, v56
    v_mfma_f32_32x32x16_bf16 v[64:79], v[108:111], v[12:15], v[64:79]
    ds_read_b128 v[104:107], v3 offset:32768
    ds_read_b128 v[108:111], v3 offset:33792
    v_cvt_pk_bf16_f32 v99, v54, v55
    v_exp_f32 v57, v57
    v_exp_f32 v58, v58
    v_exp_f32 v59, v59
    v_mfma_f32_32x32x16_bf16 v[80:95], v[112:115], v[96:99], v[80:95]
    ds_read_b128 v[112:115], v3 offset:14336
    v_cvt_pk_bf16_f32 v100, v56, v57
    v_exp_f32 v60, v60
    v_exp_f32 v61, v61
    v_cvt_pk_bf16_f32 v101, v58, v59
    s_add_u32 m0, s35, 131072
    s_nop 0
    buffer_load_dwordx4 v2, s[16:19], s32 offen offset:0 sc1 lds
    v_exp_f32 v62, v62
    v_exp_f32 v63, v63
    v_cvt_pk_bf16_f32 v102, v60, v61
    buffer_load_dwordx4 v2, s[16:19], s32 offen offset:1024 sc1 lds
    buffer_load_dwordx4 v[152:155], v1, s[16:19], s79 offen offset:2048 sc1
    s_setprio 2
    v_exp_f32 v64, v64
    v_cvt_pk_bf16_f32 v103, v62, v63
    v_exp_f32 v65, v65
    v_exp_f32 v66, v66
    s_waitcnt lgkmcnt(0)
    buffer_load_dwordx4 v2, s[16:19], s32 offen offset:2048 sc1 lds
    v_smfmac_f32_16x16x64_bf16 v[20:23], v[16:19], v[96:103], v127
    v_exp_f32 v67, v67
    v_mfma_f32_32x32x16_bf16 v[80:95], v[116:119], v[100:103], v[80:95]
    ds_read_b128 v[116:119], v3 offset:15360
    v_cvt_pk_bf16_f32 v96, v64, v65
    v_exp_f32 v68, v68
    v_exp_f32 v69, v69
    v_cvt_pk_bf16_f32 v97, v66, v67
    s_waitcnt vmcnt(9)
    s_waitcnt vmcnt(4)
    ds_add_u32 v26, v27
    v_mfma_f32_32x32x16_bf16 v[48:63], v[104:107], v[8:11], v[32:47]
    v_exp_f32 v70, v70
    v_exp_f32 v71, v71
    v_cvt_pk_bf16_f32 v98, v68, v69
    v_exp_f32 v72, v72
    v_mfma_f32_32x32x16_bf16 v[48:63], v[108:111], v[12:15], v[48:63]
    ds_read_b128 v[104:107], v3 offset:36864
    ds_read_b128 v[108:111], v3 offset:37888
    v_cvt_pk_bf16_f32 v99, v70, v71
    v_exp_f32 v73, v73
    v_exp_f32 v74, v74
    v_exp_f32 v75, v75
    v_mfma_f32_32x32x16_bf16 v[80:95], v[112:115], v[96:99], v[80:95]
    ds_read_b128 v[112:115], v3 offset:34816
    v_cvt_pk_bf16_f32 v100, v72, v73
    v_exp_f32 v76, v76
    v_exp_f32 v77, v77
    v_cvt_pk_bf16_f32 v101, v74, v75
    buffer_load_dwordx4 v2, s[16:19], s32 offen offset:3072 sc1 lds
    v_exp_f32 v78, v78
    v_exp_f32 v79, v79
    v_cvt_pk_bf16_f32 v102, v76, v77
    buffer_load_dwordx4 v[156:159], v1, s[16:19], s79 offen offset:3072 sc1
    s_setprio 1
    v_exp_f32 v48, v48
    v_cvt_pk_bf16_f32 v103, v78, v79
    v_exp_f32 v49, v49
    v_exp_f32 v50, v50
    s_waitcnt lgkmcnt(0)
    v_smfmac_f32_16x16x64_bf16 v[20:23], v[16:19], v[96:103], v127
    v_exp_f32 v51, v51
    v_mfma_f32_32x32x16_bf16 v[80:95], v[116:119], v[100:103], v[80:95]
    ds_read_b128 v[116:119], v3 offset:35840
    v_cvt_pk_bf16_f32 v96, v48, v49
    v_exp_f32 v52, v52
    v_exp_f32 v53, v53
    v_cvt_pk_bf16_f32 v97, v50, v51
    v_mfma_f32_32x32x16_bf16 v[64:79], v[104:107], v[8:11], v[32:47]
    v_exp_f32 v54, v54
    v_exp_f32 v55, v55
    v_cvt_pk_bf16_f32 v98, v52, v53
    v_exp_f32 v56, v56
    v_mfma_f32_32x32x16_bf16 v[64:79], v[108:111], v[12:15], v[64:79]
    ds_read_b128 v[104:107], v3 offset:40960
    ds_read_b128 v[108:111], v3 offset:41984
    v_cvt_pk_bf16_f32 v99, v54, v55
    v_exp_f32 v57, v57
    v_exp_f32 v58, v58
    v_exp_f32 v59, v59
    v_mfma_f32_32x32x16_bf16 v[80:95], v[112:115], v[96:99], v[80:95]
    ds_read_b128 v[112:115], v3 offset:38912
    v_cvt_pk_bf16_f32 v100, v56, v57
    v_exp_f32 v60, v60
    v_exp_f32 v61, v61
    v_cvt_pk_bf16_f32 v101, v58, v59
    v_exp_f32 v62, v62
    v_exp_f32 v63, v63
    v_cvt_pk_bf16_f32 v102, v60, v61
    s_bfe_u32 s5, s85, 0x20002
    s_lshl_b32 s5, s5, 13
    s_add_u32 s79, s82, s5
    buffer_load_dwordx4 v[160:163], v1, s[16:19], s79 offen offset:0 sc1
    s_setprio 0
    v_exp_f32 v64, v64
    v_cvt_pk_bf16_f32 v103, v62, v63
    v_exp_f32 v65, v65
    v_exp_f32 v66, v66
    s_waitcnt lgkmcnt(0)
    v_smfmac_f32_16x16x64_bf16 v[20:23], v[16:19], v[96:103], v127
    v_exp_f32 v67, v67
    v_mfma_f32_32x32x16_bf16 v[80:95], v[116:119], v[100:103], v[80:95]
    ds_read_b128 v[116:119], v3 offset:39936
    v_cvt_pk_bf16_f32 v96, v64, v65
    v_exp_f32 v68, v68
    v_exp_f32 v69, v69
    v_cvt_pk_bf16_f32 v97, v66, v67
    v_mfma_f32_32x32x16_bf16 v[48:63], v[104:107], v[8:11], v[32:47]
    v_exp_f32 v70, v70
    v_exp_f32 v71, v71
    v_cvt_pk_bf16_f32 v98, v68, v69
    v_exp_f32 v72, v72
    v_mfma_f32_32x32x16_bf16 v[48:63], v[108:111], v[12:15], v[48:63]
    ds_read_b128 v[104:107], v3 offset:45056
    ds_read_b128 v[108:111], v3 offset:46080
    v_cvt_pk_bf16_f32 v99, v70, v71
    v_exp_f32 v73, v73
    v_exp_f32 v74, v74
    v_exp_f32 v75, v75
    v_mfma_f32_32x32x16_bf16 v[80:95], v[112:115], v[96:99], v[80:95]
    ds_read_b128 v[112:115], v3 offset:43008
    v_cvt_pk_bf16_f32 v100, v72, v73
    v_exp_f32 v76, v76
    v_exp_f32 v77, v77
    v_cvt_pk_bf16_f32 v101, v74, v75
    v_exp_f32 v78, v78
    v_exp_f32 v79, v79
    v_cvt_pk_bf16_f32 v102, v76, v77
    s_add_u32 s50, s50, 32768
    s_and_b32 s50, s50, 0x7ffff
    s_or_b32 s32, s50, s34
    s_add_u32 m0, s35, 0
    buffer_load_dwordx4 v[164:167], v1, s[16:19], s79 offen offset:1024 sc1
    ds_read_b32 v125, v26
    s_setprio 3
    v_exp_f32 v48, v48
    v_cvt_pk_bf16_f32 v103, v78, v79
    v_exp_f32 v49, v49
    v_exp_f32 v50, v50
    s_waitcnt lgkmcnt(0)
    v_readfirstlane_b32 s5, v125
    v_smfmac_f32_16x16x64_bf16 v[20:23], v[16:19], v[96:103], v127
    v_exp_f32 v51, v51
    v_mfma_f32_32x32x16_bf16 v[80:95], v[116:119], v[100:103], v[80:95]
    ds_read_b128 v[116:119], v3 offset:44032
    v_cvt_pk_bf16_f32 v96, v48, v49
    v_exp_f32 v52, v52
    v_exp_f32 v53, v53
    v_cvt_pk_bf16_f32 v97, v50, v51
    s_cmp_lt_u32 s5, 88
    s_cbranch_scc1 Lool_98
Lret_99:
    v_mfma_f32_32x32x16_bf16 v[64:79], v[104:107], v[8:11], v[32:47]
    v_exp_f32 v54, v54
    v_exp_f32 v55, v55
    v_cvt_pk_bf16_f32 v98, v52, v53
    v_exp_f32 v56, v56
    v_mfma_f32_32x32x16_bf16 v[64:79], v[108:111], v[12:15], v[64:79]
    ds_read_b128 v[104:107], v6 offset:0
    ds_read_b128 v[108:111], v6 offset:1024
    v_cvt_pk_bf16_f32 v99, v54, v55
    v_exp_f32 v57, v57
    v_exp_f32 v58, v58
    v_exp_f32 v59, v59
    v_mfma_f32_32x32x16_bf16 v[80:95], v[112:115], v[96:99], v[80:95]
    ds_read_b128 v[112:115], v3 offset:47104
    v_cvt_pk_bf16_f32 v100, v56, v57
    v_exp_f32 v60, v60
    v_exp_f32 v61, v61
    v_cvt_pk_bf16_f32 v101, v58, v59
    buffer_load_dwordx4 v2, s[16:19], s32 offen offset:0 sc1 lds
    v_exp_f32 v62, v62
    v_exp_f32 v63, v63
    v_cvt_pk_bf16_f32 v102, v60, v61
    buffer_load_dwordx4 v2, s[16:19], s32 offen offset:1024 sc1 lds
    buffer_load_dwordx4 v[168:171], v1, s[16:19], s79 offen offset:2048 sc1
    s_cmp_lt_u32 s22, 2
    s_cbranch_scc1 Lool_102
Lret_103:
    s_setprio 2
    v_exp_f32 v64, v64
    v_cvt_pk_bf16_f32 v103, v62, v63
    v_exp_f32 v65, v65
    v_exp_f32 v66, v66
    s_waitcnt lgkmcnt(0)
    buffer_load_dwordx4 v2, s[16:19], s32 offen offset:2048 sc1 lds
    v_smfmac_f32_16x16x64_bf16 v[20:23], v[16:19], v[96:103], v127
    v_exp_f32 v67, v67
    v_mfma_f32_32x32x16_bf16 v[80:95], v[116:119], v[100:103], v[80:95]
    ds_read_b128 v[116:119], v3 offset:48128
    v_cvt_pk_bf16_f32 v96, v64, v65
    v_exp_f32 v68, v68
    v_exp_f32 v69, v69
    v_cvt_pk_bf16_f32 v97, v66, v67
    s_waitcnt vmcnt(7)
    ds_add_u32 v26, v27
    v_mfma_f32_32x32x16_bf16 v[48:63], v[104:107], v[8:11], v[32:47]
    v_exp_f32 v70, v70
    v_exp_f32 v71, v71
    v_cvt_pk_bf16_f32 v98, v68, v69
    v_exp_f32 v72, v72
    v_mfma_f32_32x32x16_bf16 v[48:63], v[108:111], v[12:15], v[48:63]
    ds_read_b128 v[104:107], v6 offset:4096
    ds_read_b128 v[108:111], v6 offset:5120
    v_cvt_pk_bf16_f32 v99, v70, v71
    v_exp_f32 v73, v73
    v_exp_f32 v74, v74
    v_exp_f32 v75, v75
    v_mfma_f32_32x32x16_bf16 v[80:95], v[112:115], v[96:99], v[80:95]
    ds_read_b128 v[112:115], v6 offset:2048
    v_cvt_pk_bf16_f32 v100, v72, v73
    v_exp_f32 v76, v76
    v_exp_f32 v77, v77
    v_cvt_pk_bf16_f32 v101, v74, v75
    buffer_load_dwordx4 v2, s[16:19], s32 offen offset:3072 sc1 lds
    v_exp_f32 v78, v78
    v_exp_f32 v79, v79
    v_cvt_pk_bf16_f32 v102, v76, v77
    buffer_load_dwordx4 v[172:175], v1, s[16:19], s79 offen offset:3072 sc1
    s_setprio 1
    v_exp_f32 v48, v48
    v_cvt_pk_bf16_f32 v103, v78, v79
    v_exp_f32 v49, v49
    v_exp_f32 v50, v50
    s_waitcnt lgkmcnt(0)
    v_smfmac_f32_16x16x64_bf16 v[20:23], v[16:19], v[96:103], v127
    v_exp_f32 v51, v51
    v_mfma_f32_32x32x16_bf16 v[80:95], v[116:119], v[100:103], v[80:95]
    ds_read_b128 v[116:119], v6 offset:3072
    v_cvt_pk_bf16_f32 v96, v48, v49
    v_exp_f32 v52, v52
    v_exp_f32 v53, v53
    v_cvt_pk_bf16_f32 v97, v50, v51
    v_mfma_f32_32x32x16_bf16 v[64:79], v[104:107], v[8:11], v[32:47]
    v_exp_f32 v54, v54
    v_exp_f32 v55, v55
    v_cvt_pk_bf16_f32 v98, v52, v53
    v_exp_f32 v56, v56
    v_mfma_f32_32x32x16_bf16 v[64:79], v[108:111], v[12:15], v[64:79]
    ds_read_b128 v[104:107], v6 offset:8192
    ds_read_b128 v[108:111], v6 offset:9216
    v_cvt_pk_bf16_f32 v99, v54, v55
    v_exp_f32 v57, v57
    v_exp_f32 v58, v58
    v_exp_f32 v59, v59
    v_mfma_f32_32x32x16_bf16 v[80:95], v[112:115], v[96:99], v[80:95]
    ds_read_b128 v[112:115], v6 offset:6144
    v_cvt_pk_bf16_f32 v100, v56, v57
    v_exp_f32 v60, v60
    v_exp_f32 v61, v61
    v_cvt_pk_bf16_f32 v101, v58, v59
    v_exp_f32 v62, v62
    v_exp_f32 v63, v63
    v_cvt_pk_bf16_f32 v102, v60, v61
    s_add_u32 s79, s79, 4096
    buffer_load_dwordx4 v[176:179], v1, s[16:19], s79 offen offset:0 sc1
    s_setprio 0
    v_exp_f32 v64, v64
    v_cvt_pk_bf16_f32 v103, v62, v63
    v_exp_f32 v65, v65
    v_exp_f32 v66, v66
    s_waitcnt lgkmcnt(0)
    v_smfmac_f32_16x16x64_bf16 v[20:23], v[16:19], v[96:103], v127
    v_exp_f32 v67, v67
    v_mfma_f32_32x32x16_bf16 v[80:95], v[116:119], v[100:103], v[80:95]
    ds_read_b128 v[116:119], v6 offset:7168
    v_cvt_pk_bf16_f32 v96, v64, v65
    v_exp_f32 v68, v68
    v_exp_f32 v69, v69
    v_cvt_pk_bf16_f32 v97, v66, v67
    v_mfma_f32_32x32x16_bf16 v[48:63], v[104:107], v[8:11], v[32:47]
    v_exp_f32 v70, v70
    v_exp_f32 v71, v71
    v_cvt_pk_bf16_f32 v98, v68, v69
    v_exp_f32 v72, v72
    v_mfma_f32_32x32x16_bf16 v[48:63], v[108:111], v[12:15], v[48:63]
    ds_read_b128 v[104:107], v6 offset:12288
    ds_read_b128 v[108:111], v6 offset:13312
    v_cvt_pk_bf16_f32 v99, v70, v71
    v_exp_f32 v73, v73
    v_exp_f32 v74, v74
    v_exp_f32 v75, v75
    v_mfma_f32_32x32x16_bf16 v[80:95], v[112:115], v[96:99], v[80:95]
    ds_read_b128 v[112:115], v6 offset:10240
    v_cvt_pk_bf16_f32 v100, v72, v73
    v_exp_f32 v76, v76
    v_exp_f32 v77, v77
    v_cvt_pk_bf16_f32 v101, v74, v75
    v_exp_f32 v78, v78
    v_exp_f32 v79, v79
    v_cvt_pk_bf16_f32 v102, v76, v77
    s_add_u32 s50, s50, 32768
    s_and_b32 s50, s50, 0x7ffff
    s_or_b32 s32, s50, s34
    s_add_u32 m0, s35, 32768
    buffer_load_dwordx4 v[180:183], v1, s[16:19], s79 offen offset:1024 sc1
    ds_read_b32 v125, v26
    s_setprio 3
    v_exp_f32 v48, v48
    v_cvt_pk_bf16_f32 v103, v78, v79
    v_exp_f32 v49, v49
    v_exp_f32 v50, v50
    s_waitcnt lgkmcnt(0)
    v_readfirstlane_b32 s5, v125
    v_smfmac_f32_16x16x64_bf16 v[20:23], v[16:19], v[96:103], v127
    v_exp_f32 v51, v51
    v_mfma_f32_32x32x16_bf16 v[80:95], v[116:119], v[100:103], v[80:95]
    ds_read_b128 v[116:119], v6 offset:11264
    v_cvt_pk_bf16_f32 v96, v48, v49
    v_exp_f32 v52, v52
    v_exp_f32 v53, v53
    v_cvt_pk_bf16_f32 v97, v50, v51
    s_cmp_lt_u32 s5, 96
    s_cbranch_scc1 Lool_107
Lret_108:
    v_mfma_f32_32x32x16_bf16 v[64:79], v[104:107], v[8:11], v[32:47]
    v_exp_f32 v54, v54
    v_exp_f32 v55, v55
    v_cvt_pk_bf16_f32 v98, v52, v53
    v_exp_f32 v56, v56
    v_mfma_f32_32x32x16_bf16 v[64:79], v[108:111], v[12:15], v[64:79]
    ds_read_b128 v[104:107], v7 offset:0
    ds_read_b128 v[108:111], v7 offset:1024
    v_cvt_pk_bf16_f32 v99, v54, v55
    v_exp_f32 v57, v57
    v_exp_f32 v58, v58
    v_exp_f32 v59, v59
    v_mfma_f32_32x32x16_bf16 v[80:95], v[112:115], v[96:99], v[80:95]
    ds_read_b128 v[112:115], v6 offset:14336
    v_cvt_pk_bf16_f32 v100, v56, v57
    v_exp_f32 v60, v60
    v_exp_f32 v61, v61
    v_cvt_pk_bf16_f32 v101, v58, v59
    buffer_load_dwordx4 v2, s[16:19], s32 offen offset:0 sc1 lds
    v_exp_f32 v62, v62
    v_exp_f32 v63, v63
    v_cvt_pk_bf16_f32 v102, v60, v61
    buffer_load_dwordx4 v2, s[16:19], s32 offen offset:1024 sc1 lds
    buffer_load_dwordx4 v[184:187], v1, s[16:19], s79 offen offset:2048 sc1
    ds_read2_b64 v[224:227], v124 offset0:0 offset1:2
    s_setprio 2
    v_exp_f32 v64, v64
    v_cvt_pk_bf16_f32 v103, v62, v63
    v_exp_f32 v65, v65
    v_exp_f32 v66, v66
    s_waitcnt lgkmcnt(0)
    buffer_load_dwordx4 v2, s[16:19], s32 offen offset:2048 sc1 lds
    v_smfmac_f32_16x16x64_bf16 v[20:23], v[16:19], v[96:103], v127
    v_exp_f32 v67, v67
    v_mfma_f32_32x32x16_bf16 v[80:95], v[116:119], v[100:103], v[80:95]
    ds_read_b128 v[116:119], v6 offset:15360
    v_cvt_pk_bf16_f32 v96, v64, v65
    v_exp_f32 v68, v68
    v_exp_f32 v69, v69
    v_cvt_pk_bf16_f32 v97, v66, v67
    s_waitcnt vmcnt(7)
    ds_add_u32 v26, v27
    v_mfma_f32_32x32x16_bf16 v[48:63], v[104:107], v[8:11], v[32:47]
    v_exp_f32 v70, v70
    v_exp_f32 v71, v71
    v_cvt_pk_bf16_f32 v98, v68, v69
    v_exp_f32 v72, v72
    v_mfma_f32_32x32x16_bf16 v[48:63], v[108:111], v[12:15], v[48:63]
    ds_read_b128 v[104:107], v7 offset:4096
    ds_read_b128 v[108:111], v7 offset:5120
    v_cvt_pk_bf16_f32 v99, v70, v71
    v_exp_f32 v73, v73
    v_exp_f32 v74, v74
    v_exp_f32 v75, v75
    v_mfma_f32_32x32x16_bf16 v[80:95], v[112:115], v[96:99], v[80:95]
    ds_read_b128 v[112:115], v7 offset:2048
    v_cvt_pk_bf16_f32 v100, v72, v73
    v_exp_f32 v76, v76
    v_exp_f32 v77, v77
    v_cvt_pk_bf16_f32 v101, v74, v75
    buffer_load_dwordx4 v2, s[16:19], s32 offen offset:3072 sc1 lds
    v_mfma_f32_32x32x16_bf16 v[240:255], v[224:227], v[208:211], 0
    v_exp_f32 v78, v78
    v_exp_f32 v79, v79
    v_cvt_pk_bf16_f32 v102, v76, v77
    buffer_load_dwordx4 v[188:191], v1, s[16:19], s79 offen offset:3072 sc1
    ds_read2_b64 v[228:231], v124 offset0:4 offset1:6
    s_setprio 1
    v_exp_f32 v48, v48
    v_cvt_pk_bf16_f32 v103, v78, v79
    v_exp_f32 v49, v49
    v_exp_f32 v50, v50
    s_waitcnt lgkmcnt(0)
    v_smfmac_f32_16x16x64_bf16 v[20:23], v[16:19], v[96:103], v127
    v_exp_f32 v51, v51
    v_mfma_f32_32x32x16_bf16 v[80:95], v[116:119], v[100:103], v[80:95]
    ds_read_b128 v[116:119], v7 offset:3072
    v_cvt_pk_bf16_f32 v96, v48, v49
    v_exp_f32 v52, v52
    v_exp_f32 v53, v53
    v_cvt_pk_bf16_f32 v97, v50, v51
    v_mfma_f32_32x32x16_bf16 v[64:79], v[104:107], v[8:11], v[32:47]
    v_exp_f32 v54, v54
    v_exp_f32 v55, v55
    v_cvt_pk_bf16_f32 v98, v52, v53
    v_exp_f32 v56, v56
    v_mfma_f32_32x32x16_bf16 v[64:79], v[108:111], v[12:15], v[64:79]
    ds_read_b128 v[104:107], v7 offset:8192
    ds_read_b128 v[108:111], v7 offset:9216
    v_cvt_pk_bf16_f32 v99, v54, v55
    v_exp_f32 v57, v57
    v_exp_f32 v58, v58
    v_exp_f32 v59, v59
    v_mfma_f32_32x32x16_bf16 v[80:95], v[112:115], v[96:99], v[80:95]
    ds_read_b128 v[112:115], v7 offset:6144
    v_cvt_pk_bf16_f32 v100, v56, v57
    v_exp_f32 v60, v60
    v_exp_f32 v61, v61
    v_cvt_pk_bf16_f32 v101, v58, v59
    v_mfma_f32_32x32x16_bf16 v[240:255], v[228:231], v[212:215], v[240:255]
    v_bfe_u32 v4, v0, 2, 1
    v_and_b32 v5, 3, v0
    v_lshlrev_b32 v4, 12, v4
    v_lshl_add_u32 v120, v5, 9, v4
    buffer_load_dword v29, v120, s[16:19], s31 offen sc1
    v_exp_f32 v62, v62
    v_exp_f32 v63, v63
    v_cvt_pk_bf16_f32 v102, v60, v61
    s_bfe_u32 s5, s85, 0x20004
    s_lshl_b32 s5, s5, 13
    s_add_u32 s79, s82, s5
    buffer_load_dwordx4 v[192:195], v1, s[16:19], s79 offen offset:0 sc1
    ds_read2_b64 v[232:235], v124 offset0:8 offset1:10
    s_setprio 0
    v_exp_f32 v64, v64
    v_cvt_pk_bf16_f32 v103, v62, v63
    v_exp_f32 v65, v65
    v_exp_f32 v66, v66
    s_waitcnt lgkmcnt(0)
    v_smfmac_f32_16x16x64_bf16 v[20:23], v[16:19], v[96:103], v127
    v_exp_f32 v67, v67
    v_mfma_f32_32x32x16_bf16 v[80:95], v[116:119], v[100:103], v[80:95]
    ds_read_b128 v[116:119], v7 offset:7168
    v_cvt_pk_bf16_f32 v96, v64, v65
    v_exp_f32 v68, v68
    v_exp_f32 v69, v69
    v_cvt_pk_bf16_f32 v97, v66, v67
    v_mfma_f32_32x32x16_bf16 v[48:63], v[104:107], v[8:11], v[32:47]
    v_exp_f32 v70, v70
    v_exp_f32 v71, v71
    v_cvt_pk_bf16_f32 v98, v68, v69
    v_exp_f32 v72, v72
    v_mfma_f32_32x32x16_bf16 v[48:63], v[108:111], v[12:15], v[48:63]
    ds_read_b128 v[104:107], v7 offset:12288
    ds_read_b128 v[108:111], v7 offset:13312
    v_cvt_pk_bf16_f32 v99, v70, v71
    v_exp_f32 v73, v73
    v_exp_f32 v74, v74
    v_exp_f32 v75, v75
    v_mfma_f32_32x32x16_bf16 v[80:95], v[112:115], v[96:99], v[80:95]
    ds_read_b128 v[112:115], v7 offset:10240
    v_cvt_pk_bf16_f32 v100, v72, v73
    v_exp_f32 v76, v76
    v_exp_f32 v77, v77
    v_cvt_pk_bf16_f32 v101, v74, v75
    v_mfma_f32_32x32x16_bf16 v[240:255], v[232:235], v[216:219], v[240:255]
    s_add_u32 m0, s77, 106496
    s_add_u32 s78, s49, 0
    buffer_load_dwordx4 v28, s[8:11], s78 offen lds
    v_exp_f32 v78, v78
    v_exp_f32 v79, v79
    v_cvt_pk_bf16_f32 v102, v76, v77
    buffer_load_dwordx4 v[196:199], v1, s[16:19], s79 offen offset:1024 sc1
    ds_read2_b64 v[236:239], v124 offset0:12 offset1:14
    ds_read_b32 v125, v26
    s_setprio 3
    v_exp_f32 v48, v48
    v_cvt_pk_bf16_f32 v103, v78, v79
    v_exp_f32 v49, v49
    v_exp_f32 v50, v50
    s_waitcnt lgkmcnt(0)
    v_readfirstlane_b32 s5, v125
    v_smfmac_f32_16x16x64_bf16 v[20:23], v[16:19], v[96:103], v127
    v_exp_f32 v51, v51
    v_mfma_f32_32x32x16_bf16 v[80:95], v[116:119], v[100:103], v[80:95]
    ds_read_b128 v[116:119], v7 offset:11264
    v_cvt_pk_bf16_f32 v96, v48, v49
    v_exp_f32 v52, v52
    v_exp_f32 v53, v53
    v_cvt_pk_bf16_f32 v97, v50, v51
    s_cmp_lt_u32 s5, 104
    s_cbranch_scc1 Lool_111
Lret_112:
    v_mfma_f32_32x32x16_bf16 v[64:79], v[104:107], v[8:11], v[32:47]
    v_exp_f32 v54, v54
    v_exp_f32 v55, v55
    v_cvt_pk_bf16_f32 v98, v52, v53
    v_exp_f32 v56, v56
    v_mfma_f32_32x32x16_bf16 v[64:79], v[108:111], v[12:15], v[64:79]
    ds_read_b128 v[104:107], v3 offset:0
    ds_read_b128 v[108:111], v3 offset:1024
    v_cvt_pk_bf16_f32 v99, v54, v55
    v_exp_f32 v57, v57
    v_exp_f32 v58, v58
    v_exp_f32 v59, v59
    v_mfma_f32_32x32x16_bf16 v[80:95], v[112:115], v[96:99], v[80:95]
    ds_read_b128 v[112:115], v7 offset:14336
    v_cvt_pk_bf16_f32 v100, v56, v57
    v_exp_f32 v60, v60
    v_exp_f32 v61, v61
    v_cvt_pk_bf16_f32 v101, v58, v59
    v_mfma_f32_32x32x16_bf16 v[240:255], v[236:239], v[220:223], v[240:255]
    s_add_u32 m0, s77, 114688
    s_add_u32 s78, s49, 32768
    buffer_load_dwordx4 v28, s[8:11], s78 offen lds
    v_exp_f32 v62, v62
    v_exp_f32 v63, v63
    v_cvt_pk_bf16_f32 v102, v60, v61
    buffer_load_dwordx4 v[200:203], v1, s[16:19], s79 offen offset:2048 sc1
    s_setprio 2
    v_exp_f32 v64, v64
    v_cvt_pk_bf16_f32 v103, v62, v63
    v_exp_f32 v65, v65
    v_exp_f32 v66, v66
    s_waitcnt lgkmcnt(0)
    v_smfmac_f32_16x16x64_bf16 v[20:23], v[16:19], v[96:103], v127
    v_exp_f32 v67, v67
    v_mfma_f32_32x32x16_bf16 v[80:95], v[116:119], v[100:103], v[80:95]
    ds_read_b128 v[116:119], v7 offset:15360
    v_cvt_pk_bf16_f32 v96, v64, v65
    v_exp_f32 v68, v68
    v_exp_f32 v69, v69
    v_cvt_pk_bf16_f32 v97, v66, v67
    s_waitcnt vmcnt(7)
    ds_add_u32 v26, v27
    v_mfma_f32_32x32x16_bf16 v[48:63], v[104:107], v[8:11], v[32:47]
    v_exp_f32 v70, v70
    v_exp_f32 v71, v71
    v_cvt_pk_bf16_f32 v98, v68, v69
    v_exp_f32 v72, v72
    v_mfma_f32_32x32x16_bf16 v[48:63], v[108:111], v[12:15], v[48:63]
    ds_read_b128 v[104:107], v3 offset:4096
    ds_read_b128 v[108:111], v3 offset:5120
    v_cvt_pk_bf16_f32 v99, v70, v71
    v_exp_f32 v73, v73
    v_exp_f32 v74, v74
    v_exp_f32 v75, v75
    v_mfma_f32_32x32x16_bf16 v[80:95], v[112:115], v[96:99], v[80:95]
    ds_read_b128 v[112:115], v3 offset:2048
    v_cvt_pk_bf16_f32 v100, v72, v73
    v_exp_f32 v76, v76
    v_exp_f32 v77, v77
    v_cvt_pk_bf16_f32 v101, v74, v75
    v_exp_f32 v78, v78
    v_exp_f32 v79, v79
    v_cvt_pk_bf16_f32 v102, v76, v77
    buffer_load_dwordx4 v[204:207], v1, s[16:19], s79 offen offset:3072 sc1
    v_lshlrev_b32 v4, 3, v0
    v_mov_b32_dpp v242, v240 quad_perm:[1,1,3,3] row_mask:0xf bank_mask:0xf
    v_mov_b32 v241, s25
    v_mov_b32 v243, s25
    s_mov_b64 exec, 0x55555555
    buffer_store_dwordx4 v[240:243], v4, s[16:19], s45 offen sc1
    s_mov_b64 exec, -1
    s_setprio 1
    v_exp_f32 v48, v48
    v_cvt_pk_bf16_f32 v103, v78, v79
    v_exp_f32 v49, v49
    v_exp_f32 v50, v50
    s_waitcnt lgkmcnt(0)
    v_smfmac_f32_16x16x64_bf16 v[20:23], v[16:19], v[96:103], v127
    v_exp_f32 v51, v51
    v_mfma_f32_32x32x16_bf16 v[80:95], v[116:119], v[100:103], v[80:95]
    ds_read_b128 v[116:119], v3 offset:3072
    v_cvt_pk_bf16_f32 v96, v48, v49
    v_exp_f32 v52, v52
    v_exp_f32 v53, v53
    v_cvt_pk_bf16_f32 v97, v50, v51
    v_mfma_f32_32x32x16_bf16 v[64:79], v[104:107], v[8:11], v[32:47]
    v_exp_f32 v54, v54
    v_exp_f32 v55, v55
    v_cvt_pk_bf16_f32 v98, v52, v53
    v_exp_f32 v56, v56
    v_mfma_f32_32x32x16_bf16 v[64:79], v[108:111], v[12:15], v[64:79]
    ds_read_b128 v[104:107], v3 offset:8192
    ds_read_b128 v[108:111], v3 offset:9216
    v_cvt_pk_bf16_f32 v99, v54, v55
    v_exp_f32 v57, v57
    v_exp_f32 v58, v58
    v_exp_f32 v59, v59
    v_mfma_f32_32x32x16_bf16 v[80:95], v[112:115], v[96:99], v[80:95]
    ds_read_b128 v[112:115], v3 offset:6144
    v_cvt_pk_bf16_f32 v100, v56, v57
    v_exp_f32 v60, v60
    v_exp_f32 v61, v61
    v_cvt_pk_bf16_f32 v101, v58, v59
    s_waitcnt vmcnt(7)
    v_or_b32 v29, 1, v29
    s_or_b32 s5, s25, 1
    v_cmp_ne_u32 s[80:81], s5, v29
    v_exp_f32 v62, v62
    v_exp_f32 v63, v63
    v_cvt_pk_bf16_f32 v102, v60, v61
    s_setprio 0
    v_exp_f32 v64, v64
    v_cvt_pk_bf16_f32 v103, v62, v63
    v_exp_f32 v65, v65
    v_exp_f32 v66, v66
    s_waitcnt lgkmcnt(0)
    v_smfmac_f32_16x16x64_bf16 v[20:23], v[16:19], v[96:103], v127
    v_exp_f32 v67, v67
    v_mfma_f32_32x32x16_bf16 v[80:95], v[116:119], v[100:103], v[80:95]
    ds_read_b128 v[116:119], v3 offset:7168
    v_cvt_pk_bf16_f32 v96, v64, v65
    v_exp_f32 v68, v68
    v_exp_f32 v69, v69
    v_cvt_pk_bf16_f32 v97, v66, v67
    v_mfma_f32_32x32x16_bf16 v[48:63], v[104:107], v[8:11], v[32:47]
    v_exp_f32 v70, v70
    v_exp_f32 v71, v71
    v_cvt_pk_bf16_f32 v98, v68, v69
    v_exp_f32 v72, v72
    v_mfma_f32_32x32x16_bf16 v[48:63], v[108:111], v[12:15], v[48:63]
    ds_read_b128 v[104:107], v3 offset:12288
    ds_read_b128 v[108:111], v3 offset:13312
    v_cvt_pk_bf16_f32 v99, v70, v71
    v_exp_f32 v73, v73
    v_exp_f32 v74, v74
    v_exp_f32 v75, v75
    v_mfma_f32_32x32x16_bf16 v[80:95], v[112:115], v[96:99], v[80:95]
    ds_read_b128 v[112:115], v3 offset:10240
    v_cvt_pk_bf16_f32 v100, v72, v73
    v_exp_f32 v76, v76
    v_exp_f32 v77, v77
    v_cvt_pk_bf16_f32 v101, v74, v75
    v_exp_f32 v78, v78
    v_exp_f32 v79, v79
    v_cvt_pk_bf16_f32 v102, v76, v77
    s_add_u32 s79, s79, 4096
    buffer_load_dwordx4 v[208:211], v1, s[16:19], s79 offen offset:0 sc1
    ds_read_b32 v125, v26
    s_setprio 3
    v_exp_f32 v48, v48
    v_cvt_pk_bf16_f32 v103, v78, v79
    v_exp_f32 v49, v49
    v_exp_f32 v50, v50
    s_waitcnt lgkmcnt(0)
    v_readfirstlane_b32 s5, v125
    v_smfmac_f32_16x16x64_bf16 v[20:23], v[16:19], v[96:103], v127
    v_exp_f32 v51, v51
    v_mfma_f32_32x32x16_bf16 v[80:95], v[116:119], v[100:103], v[80:95]
    ds_read_b128 v[116:119], v3 offset:11264
    v_cvt_pk_bf16_f32 v96, v48, v49
    v_exp_f32 v52, v52
    v_exp_f32 v53, v53
    v_cvt_pk_bf16_f32 v97, v50, v51
    s_cmp_lt_u32 s5, 112
    s_cbranch_scc1 Lool_115
Lret_116:
    v_mfma_f32_32x32x16_bf16 v[64:79], v[104:107], v[8:11], v[32:47]
    v_exp_f32 v54, v54
    v_exp_f32 v55, v55
    v_cvt_pk_bf16_f32 v98, v52, v53
    v_exp_f32 v56, v56
    v_mfma_f32_32x32x16_bf16 v[64:79], v[108:111], v[12:15], v[64:79]
    ds_read_b128 v[104:107], v3 offset:32768
    ds_read_b128 v[108:111], v3 offset:33792
    v_cvt_pk_bf16_f32 v99, v54, v55
    v_exp_f32 v57, v57
    v_exp_f32 v58, v58
    v_exp_f32 v59, v59
    v_mfma_f32_32x32x16_bf16 v[80:95], v[112:115], v[96:99], v[80:95]
    ds_read_b128 v[112:115], v3 offset:14336
    v_cvt_pk_bf16_f32 v100, v56, v57
    v_exp_f32 v60, v60
    v_exp_f32 v61, v61
    v_cvt_pk_bf16_f32 v101, v58, v59
    v_exp_f32 v62, v62
    v_exp_f32 v63, v63
    v_cvt_pk_bf16_f32 v102, v60, v61
    buffer_load_dwordx4 v[212:215], v1, s[16:19], s79 offen offset:1024 sc1
    s_setprio 2
    v_exp_f32 v64, v64
    v_cvt_pk_bf16_f32 v103, v62, v63
    v_exp_f32 v65, v65
    v_exp_f32 v66, v66
    s_waitcnt lgkmcnt(0)
    v_smfmac_f32_16x16x64_bf16 v[20:23], v[16:19], v[96:103], v127
    v_exp_f32 v67, v67
    v_mfma_f32_32x32x16_bf16 v[80:95], v[116:119], v[100:103], v[80:95]
    ds_read_b128 v[116:119], v3 offset:15360
    v_cvt_pk_bf16_f32 v96, v64, v65
    v_exp_f32 v68, v68
    v_exp_f32 v69, v69
    v_cvt_pk_bf16_f32 v97, v66, v67
    v_mfma_f32_32x32x16_bf16 v[48:63], v[104:107], v[8:11], v[32:47]
    v_exp_f32 v70, v70
    v_exp_f32 v71, v71
    v_cvt_pk_bf16_f32 v98, v68, v69
    v_exp_f32 v72, v72
    v_mfma_f32_32x32x16_bf16 v[48:63], v[108:111], v[12:15], v[48:63]
    ds_read_b128 v[104:107], v3 offset:36864
    ds_read_b128 v[108:111], v3 offset:37888
    v_cvt_pk_bf16_f32 v99, v70, v71
    v_exp_f32 v73, v73
    v_exp_f32 v74, v74
    v_exp_f32 v75, v75
    v_mfma_f32_32x32x16_bf16 v[80:95], v[112:115], v[96:99], v[80:95]
    ds_read_b128 v[112:115], v3 offset:34816
    v_cvt_pk_bf16_f32 v100, v72, v73
    v_exp_f32 v76, v76
    v_exp_f32 v77, v77
    v_cvt_pk_bf16_f32 v101, v74, v75
    v_exp_f32 v78, v78
    v_exp_f32 v79, v79
    v_cvt_pk_bf16_f32 v102, v76, v77
    buffer_load_dwordx4 v[216:219], v1, s[16:19], s79 offen offset:2048 sc1
    v_and_b32 v4, 31, v0
    v_lshlrev_b32 v4, 11, v4
    v_add_u32 v4, s49, v4
    v_lshrrev_b32 v29, 8, v4
    s_mov_b32 s5, 0x1004000
    buffer_load_dwordx2 v[30:31], v29, s[16:19], s5 offen sc1
    v_lshrrev_b32 v5, 5, v0
    v_lshl_add_u32 v4, v5, 3, v4
    s_lshl_b32 s6, s29, 8
    s_and_b32 s7, s22, 3
    s_lshl_b32 s7, s7, 6
    s_add_u32 s6, s6, s7
    v_add_u32 v28, s6, v4
    s_setprio 1
    v_exp_f32 v48, v48
    v_cvt_pk_bf16_f32 v103, v78, v79
    v_exp_f32 v49, v49
    v_exp_f32 v50, v50
    s_waitcnt lgkmcnt(0)
    v_smfmac_f32_16x16x64_bf16 v[20:23], v[16:19], v[96:103], v127
    v_exp_f32 v51, v51
    v_mfma_f32_32x32x16_bf16 v[80:95], v[116:119], v[100:103], v[80:95]
    ds_read_b128 v[116:119], v3 offset:35840
    v_cvt_pk_bf16_f32 v96, v48, v49
    v_exp_f32 v52, v52
    v_exp_f32 v53, v53
    v_cvt_pk_bf16_f32 v97, v50, v51
    v_mfma_f32_32x32x16_bf16 v[64:79], v[104:107], v[8:11], v[32:47]
    v_exp_f32 v54, v54
    v_exp_f32 v55, v55
    v_cvt_pk_bf16_f32 v98, v52, v53
    v_exp_f32 v56, v56
    v_mfma_f32_32x32x16_bf16 v[64:79], v[108:111], v[12:15], v[64:79]
    ds_read_b128 v[104:107], v3 offset:40960
    ds_read_b128 v[108:111], v3 offset:41984
    v_cvt_pk_bf16_f32 v99, v54, v55
    v_exp_f32 v57, v57
    v_exp_f32 v58, v58
    v_exp_f32 v59, v59
    v_mfma_f32_32x32x16_bf16 v[80:95], v[112:115], v[96:99], v[80:95]
    ds_read_b128 v[112:115], v3 offset:38912
    v_cvt_pk_bf16_f32 v100, v56, v57
    v_exp_f32 v60, v60
    v_exp_f32 v61, v61
    v_cvt_pk_bf16_f32 v101, v58, v59
    v_exp_f32 v62, v62
    v_exp_f32 v63, v63
    v_cvt_pk_bf16_f32 v102, v60, v61
    buffer_load_dwordx4 v[220:223], v1, s[16:19], s79 offen offset:3072 sc1
    s_setprio 0
    v_exp_f32 v64, v64
    v_cvt_pk_bf16_f32 v103, v62, v63
    v_exp_f32 v65, v65
    v_exp_f32 v66, v66
    s_waitcnt lgkmcnt(0)
    v_smfmac_f32_16x16x64_bf16 v[20:23], v[16:19], v[96:103], v127
    v_exp_f32 v67, v67
    v_mfma_f32_32x32x16_bf16 v[80:95], v[116:119], v[100:103], v[80:95]
    ds_read_b128 v[116:119], v3 offset:39936
    v_cvt_pk_bf16_f32 v96, v64, v65
    v_exp_f32 v68, v68
    v_exp_f32 v69, v69
    v_cvt_pk_bf16_f32 v97, v66, v67
    v_mfma_f32_32x32x16_bf16 v[48:63], v[104:107], v[8:11], v[32:47]
    v_exp_f32 v70, v70
    v_exp_f32 v71, v71
    v_cvt_pk_bf16_f32 v98, v68, v69
    v_exp_f32 v72, v72
    v_mfma_f32_32x32x16_bf16 v[48:63], v[108:111], v[12:15], v[48:63]
    ds_read_b128 v[104:107], v3 offset:45056
    ds_read_b128 v[108:111], v3 offset:46080
    v_cvt_pk_bf16_f32 v99, v70, v71
    v_exp_f32 v73, v73
    v_exp_f32 v74, v74
    v_exp_f32 v75, v75
    v_mfma_f32_32x32x16_bf16 v[80:95], v[112:115], v[96:99], v[80:95]
    ds_read_b128 v[112:115], v3 offset:43008
    v_cvt_pk_bf16_f32 v100, v72, v73
    v_exp_f32 v76, v76
    v_exp_f32 v77, v77
    v_cvt_pk_bf16_f32 v101, v74, v75
    v_exp_f32 v78, v78
    v_exp_f32 v79, v79
    v_cvt_pk_bf16_f32 v102, v76, v77
    s_setprio 3
    v_exp_f32 v48, v48
    v_cvt_pk_bf16_f32 v103, v78, v79
    v_exp_f32 v49, v49
    v_exp_f32 v50, v50
    s_waitcnt lgkmcnt(0)
    v_smfmac_f32_16x16x64_bf16 v[20:23], v[16:19], v[96:103], v127
    v_exp_f32 v51, v51
    v_mfma_f32_32x32x16_bf16 v[80:95], v[116:119], v[100:103], v[80:95]
    ds_read_b128 v[116:119], v3 offset:44032
    v_cvt_pk_bf16_f32 v96, v48, v49
    v_exp_f32 v52, v52
    v_exp_f32 v53, v53
    v_cvt_pk_bf16_f32 v97, v50, v51
    v_mfma_f32_32x32x16_bf16 v[64:79], v[104:107], v[8:11], v[32:47]
    v_exp_f32 v54, v54
    v_exp_f32 v55, v55
    v_cvt_pk_bf16_f32 v98, v52, v53
    v_exp_f32 v56, v56
    v_mfma_f32_32x32x16_bf16 v[64:79], v[108:111], v[12:15], v[64:79]
    v_cvt_pk_bf16_f32 v99, v54, v55
    v_exp_f32 v57, v57
    v_exp_f32 v58, v58
    v_exp_f32 v59, v59
    v_mfma_f32_32x32x16_bf16 v[80:95], v[112:115], v[96:99], v[80:95]
    ds_read_b128 v[112:115], v3 offset:47104
    v_cvt_pk_bf16_f32 v100, v56, v57
    v_exp_f32 v60, v60
    v_exp_f32 v61, v61
    v_cvt_pk_bf16_f32 v101, v58, v59
    v_exp_f32 v62, v62
    v_exp_f32 v63, v63
    v_cvt_pk_bf16_f32 v102, v60, v61
    s_setprio 2
    v_exp_f32 v64, v64
    v_cvt_pk_bf16_f32 v103, v62, v63
    v_exp_f32 v65, v65
    v_exp_f32 v66, v66
    s_waitcnt lgkmcnt(0)
    v_smfmac_f32_16x16x64_bf16 v[20:23], v[16:19], v[96:103], v127
    v_exp_f32 v67, v67
    v_mfma_f32_32x32x16_bf16 v[80:95], v[116:119], v[100:103], v[80:95]
    ds_read_b128 v[116:119], v3 offset:48128
    v_cvt_pk_bf16_f32 v96, v64, v65
    v_exp_f32 v68, v68
    v_exp_f32 v69, v69
    v_cvt_pk_bf16_f32 v97, v66, v67
    v_exp_f32 v70, v70
    v_exp_f32 v71, v71
    v_cvt_pk_bf16_f32 v98, v68, v69
    v_exp_f32 v72, v72
    v_cvt_pk_bf16_f32 v99, v70, v71
    v_exp_f32 v73, v73
    v_exp_f32 v74, v74
    v_exp_f32 v75, v75
    v_mfma_f32_32x32x16_bf16 v[80:95], v[112:115], v[96:99], v[80:95]
    v_cvt_pk_bf16_f32 v100, v72, v73
    v_exp_f32 v76, v76
    v_exp_f32 v77, v77
    v_cvt_pk_bf16_f32 v101, v74, v75
    v_exp_f32 v78, v78
    v_exp_f32 v79, v79
    v_cvt_pk_bf16_f32 v102, v76, v77
    s_nop 0
    v_cvt_pk_bf16_f32 v103, v78, v79
    s_nop 1
    v_smfmac_f32_16x16x64_bf16 v[20:23], v[16:19], v[96:103], v127
    s_waitcnt lgkmcnt(0)
    v_mfma_f32_32x32x16_bf16 v[80:95], v[116:119], v[100:103], v[80:95]
    s_setprio 0
    s_mov_b32 s4, 0x5f800000
    s_nop 9
    v_add_f32 v20, v20, v21
    v_cmp_nlt_f32 vcc, v20, s4
    s_nop 1
    s_cmp_lg_u64 vcc, 0
    s_cbranch_scc1 Lool_119
Lret_120:
L_fin:
    v_rcp_f32 v4, v20
    s_nop 0
    v_mul_f32 v80, v80, v4
    v_mul_f32 v81, v81, v4
    v_mul_f32 v82, v82, v4
    v_mul_f32 v83, v83, v4
    v_mul_f32 v84, v84, v4
    v_mul_f32 v85, v85, v4
    v_mul_f32 v86, v86, v4
    v_mul_f32 v87, v87, v4
    v_cvt_pk_bf16_f32 v96, v80, v81
    v_cvt_pk_bf16_f32 v97, v82, v83
    v_cvt_pk_bf16_f32 v98, v84, v85
    v_cvt_pk_bf16_f32 v99, v86, v87
    buffer_store_dwordx4 v[96:99], v1, s[16:19], s73 offen offset:0 sc1
    v_mul_f32 v88, v88, v4
    v_mul_f32 v89, v89, v4
    v_mul_f32 v90, v90, v4
    v_mul_f32 v91, v91, v4
    v_mul_f32 v92, v92, v4
    v_mul_f32 v93, v93, v4
    v_mul_f32 v94, v94, v4
    v_mul_f32 v95, v95, v4
    v_cvt_pk_bf16_f32 v100, v88, v89
    v_cvt_pk_bf16_f32 v101, v90, v91
    v_cvt_pk_bf16_f32 v102, v92, v93
    v_cvt_pk_bf16_f32 v103, v94, v95
    buffer_store_dwordx4 v[100:103], v1, s[16:19], s73 offen offset:1024 sc1
    v_mov_b32 v4, 0
    v_mov_b32 v5, s25
    s_mov_b64 exec, 1
    buffer_store_dword v5, v4, s[16:19], s95 offen sc1
    s_mov_b64 exec, -1
    s_waitcnt vmcnt(0)
    s_bfe_u32 s5, s85, 0x20000
    s_lshl_b32 s5, s5, 13
    s_add_u32 s33, s30, s5
    s_add_u32 s32, s33, 65536
    s_add_u32 m0, s84, 65536
    s_nop 0
    buffer_load_dwordx4 v1, s[16:19], s33 offen offset:0 sc1 lds
    s_add_u32 m0, s84, 65536
    s_nop 0
    buffer_load_dwordx4 v1, s[16:19], s33 offen offset:1024 sc1 lds
    s_add_u32 m0, s84, 73728
    s_nop 0
    buffer_load_dwordx4 v1, s[16:19], s32 offen offset:0 sc1 lds
    s_add_u32 m0, s84, 73728
    s_nop 0
    buffer_load_dwordx4 v1, s[16:19], s32 offen offset:1024 sc1 lds
    s_bfe_u32 s5, s85, 0x20002
    s_lshl_b32 s5, s5, 13
    s_add_u32 s33, s30, s5
    s_add_u32 s32, s33, 65536
    s_add_u32 m0, s84, 131072
    s_nop 0
    buffer_load_dwordx4 v1, s[16:19], s33 offen offset:0 sc1 lds
    s_add_u32 m0, s84, 131072
    s_nop 0
    buffer_load_dwordx4 v1, s[16:19], s33 offen offset:1024 sc1 lds
    s_add_u32 m0, s84, 139264
    s_nop 0
    buffer_load_dwordx4 v1, s[16:19], s32 offen offset:0 sc1 lds
    s_add_u32 m0, s84, 139264
    s_nop 0
    buffer_load_dwordx4 v1, s[16:19], s32 offen offset:1024 sc1 lds
    s_and_b32 s5, s84, 0x4000
    s_lshr_b32 s6, s5, 1
    s_add_u32 s5, s5, s6
    v_add_u32 v3, s5, v1
    v_xor_b32 v2, 8192, v3
    v_add_u32 v6, 65536, v2
    v_add_u32 v7, 65536, v3
    v_add_u32 v10, 131072, v2
    v_add_u32 v11, 131072, v3
    v_add_u32 v12, s84, v1
    v_add_u32 v13, 65536, v12
    v_add_u32 v14, 131072, v12
    s_lshr_b32 s7, s26, 6
    s_cmp_eq_u32 s7, s28
    s_cbranch_scc1 Lool_121
Lret_122:
    s_waitcnt vmcnt(4)
    ds_read_b32 v16, v13 offset:0
    ds_read_b32 v17, v13 offset:1024
    ds_read_b32 v18, v13 offset:8192
    ds_read_b32 v19, v13 offset:9216
    s_waitcnt lgkmcnt(1)
    v_max3_u32 v16, v16, v17, v18
    s_waitcnt lgkmcnt(0)
    v_max_u32 v16, v16, v19
    v_cmp_eq_u32 vcc, -1, v16
    s_nop 1
    s_or_b64 vcc, vcc, s[80:81]
    s_cbranch_scc1 Lool_126
Lret_127:
    s_barrier
    ds_read_b128 v[80:83], v6 offset:0
    ds_read_b128 v[84:87], v7 offset:0
    ds_read_b128 v[88:91], v6 offset:1024
    ds_read_b128 v[92:95], v7 offset:1024
    ds_read_b128 v[96:99], v6 offset:2048
    s_waitcnt lgkmcnt(4)
    v_mfma_f32_32x32x16_bf16 v[48:63], v[128:131], v[80:83], 0
    s_bfe_u32 s5, s85, 0x20004
    s_lshl_b32 s5, s5, 13
    s_add_u32 s33, s30, s5
    s_add_u32 s32, s33, 65536
    s_add_u32 m0, s84, 0
    s_nop 0
    buffer_load_dwordx4 v1, s[16:19], s33 offen offset:0 sc1 lds
    ds_read_b128 v[100:103], v7 offset:2048
    s_waitcnt lgkmcnt(4)
    v_mfma_f32_32x32x16_bf16 v[64:79], v[128:131], v[84:87], 0
    s_add_u32 m0, s84, 0
    s_nop 0
    buffer_load_dwordx4 v1, s[16:19], s33 offen offset:1024 sc1 lds
    ds_read_b128 v[80:83], v6 offset:3072
    s_waitcnt lgkmcnt(4)
    v_mfma_f32_32x32x16_bf16 v[48:63], v[132:135], v[88:91], v[48:63]
    s_add_u32 m0, s84, 8192
    s_nop 0
    buffer_load_dwordx4 v1, s[16:19], s32 offen offset:0 sc1 lds
    ds_read_b128 v[84:87], v7 offset:3072
    s_waitcnt lgkmcnt(4)
    v_mfma_f32_32x32x16_bf16 v[64:79], v[132:135], v[92:95], v[64:79]
    s_add_u32 m0, s84, 8192
    s_nop 0
    buffer_load_dwordx4 v1, s[16:19], s32 offen offset:1024 sc1 lds
    ds_read_b128 v[88:91], v6 offset:4096
    s_waitcnt lgkmcnt(4)
    v_mfma_f32_32x32x16_bf16 v[48:63], v[136:139], v[96:99], v[48:63]
    ds_read_b128 v[92:95], v7 offset:4096
    s_waitcnt lgkmcnt(4)
    v_mfma_f32_32x32x16_bf16 v[64:79], v[136:139], v[100:103], v[64:79]
    ds_read_b128 v[96:99], v6 offset:5120
    s_waitcnt lgkmcnt(4)
    v_mfma_f32_32x32x16_bf16 v[48:63], v[140:143], v[80:83], v[48:63]
    s_waitcnt vmcnt(4)
    ds_read_b32 v16, v14 offset:0
    ds_read_b32 v17, v14 offset:1024
    ds_read_b32 v18, v14 offset:8192
    ds_read_b32 v19, v14 offset:9216
    ds_read_b128 v[100:103], v7 offset:5120
    s_waitcnt lgkmcnt(8)
    v_mfma_f32_32x32x16_bf16 v[64:79], v[140:143], v[84:87], v[64:79]
    ds_read_b128 v[80:83], v6 offset:6144
    s_waitcnt lgkmcnt(8)
    v_mfma_f32_32x32x16_bf16 v[48:63], v[144:147], v[88:91], v[48:63]
    ds_read_b128 v[84:87], v7 offset:6144
    s_waitcnt lgkmcnt(8)
    v_mfma_f32_32x32x16_bf16 v[64:79], v[144:147], v[92:95], v[64:79]
    s_waitcnt lgkmcnt(4)
    v_max3_u32 v16, v16, v17, v18
    s_waitcnt lgkmcnt(3)
    v_max_u32 v16, v16, v19
    v_cmp_eq_u32 vcc, -1, v16
    s_nop 1
    s_or_b64 vcc, vcc, s[80:81]
    s_cbranch_scc1 Lool_133
Lret_134:
    ds_read_b128 v[88:91], v6 offset:7168
    v_mfma_f32_32x32x16_bf16 v[48:63], v[148:151], v[96:99], v[48:63]
    s_barrier
    ds_read_b128 v[92:95], v7 offset:7168
    s_waitcnt lgkmcnt(4)
    v_mfma_f32_32x32x16_bf16 v[64:79], v[148:151], v[100:103], v[64:79]
    s_lshl_b32 s6, s28, 1
    s_lshr_b32 s7, s22, 2
    s_add_u32 s6, s6, s7
    s_lshr_b32 s7, s26, 5
    s_cmp_eq_u32 s6, s7
    s_cbranch_scc1 Lool_140
Lret_141:
    ds_read_b128 v[96:99], v10 offset:0
    s_waitcnt lgkmcnt(4)
    v_mfma_f32_32x32x16_bf16 v[48:63], v[152:155], v[80:83], v[48:63]
    s_bfe_u32 s5, s85, 0x20006
    s_lshl_b32 s5, s5, 13
    s_add_u32 s79, s82, s5
    buffer_load_dwordx4 v[224:227], v1, s[16:19], s79 offen offset:0 sc1
    ds_read_b128 v[100:103], v11 offset:0
    s_waitcnt lgkmcnt(4)
    v_mfma_f32_32x32x16_bf16 v[64:79], v[152:155], v[84:87], v[64:79]
    buffer_load_dwordx4 v[228:231], v1, s[16:19], s79 offen offset:1024 sc1
    ds_read_b128 v[80:83], v10 offset:1024
    s_waitcnt lgkmcnt(4)
    v_mfma_f32_32x32x16_bf16 v[48:63], v[156:159], v[88:91], v[48:63]
    buffer_load_dwordx4 v[232:235], v1, s[16:19], s79 offen offset:2048 sc1
    ds_read_b128 v[84:87], v11 offset:1024
    s_waitcnt lgkmcnt(4)
    v_mfma_f32_32x32x16_bf16 v[64:79], v[156:159], v[92:95], v[64:79]
    buffer_load_dwordx4 v[236:239], v1, s[16:19], s79 offen offset:3072 sc1
    ds_read_b128 v[88:91], v10 offset:2048
    s_waitcnt lgkmcnt(4)
    v_mfma_f32_32x32x16_bf16 v[48:63], v[160:163], v[96:99], v[48:63]
    ds_read_b128 v[92:95], v11 offset:2048
    s_waitcnt lgkmcnt(4)
    v_mfma_f32_32x32x16_bf16 v[64:79], v[160:163], v[100:103], v[64:79]
    s_add_u32 s79, s79, 4096
    buffer_load_dwordx4 v[240:243], v1, s[16:19], s79 offen offset:0 sc1
    ds_read_b128 v[96:99], v10 offset:3072
    s_waitcnt lgkmcnt(4)
    v_mfma_f32_32x32x16_bf16 v[48:63], v[164:167], v[80:83], v[48:63]
    ds_read_b128 v[100:103], v11 offset:3072
    s_waitcnt lgkmcnt(4)
    v_mfma_f32_32x32x16_bf16 v[64:79], v[164:167], v[84:87], v[64:79]
    ds_read_b128 v[80:83], v10 offset:4096
    s_waitcnt lgkmcnt(4)
    v_mfma_f32_32x32x16_bf16 v[48:63], v[168:171], v[88:91], v[48:63]
    buffer_load_dwordx4 v[244:247], v1, s[16:19], s79 offen offset:1024 sc1
    ds_read_b128 v[84:87], v11 offset:4096
    s_waitcnt lgkmcnt(4)
    v_mfma_f32_32x32x16_bf16 v[64:79], v[168:171], v[92:95], v[64:79]
    ds_read_b128 v[88:91], v10 offset:5120
    s_waitcnt lgkmcnt(4)
    v_mfma_f32_32x32x16_bf16 v[48:63], v[172:175], v[96:99], v[48:63]
    s_waitcnt vmcnt(6)
    ds_read_b32 v16, v12 offset:0
    ds_read_b32 v17, v12 offset:1024
    ds_read_b32 v18, v12 offset:8192
    ds_read_b32 v19, v12 offset:9216
    ds_read_b128 v[92:95], v11 offset:5120
    s_waitcnt lgkmcnt(8)
    v_mfma_f32_32x32x16_bf16 v[64:79], v[172:175], v[100:103], v[64:79]
    buffer_load_dwordx4 v[248:251], v1, s[16:19], s79 offen offset:2048 sc1
    ds_read_b128 v[96:99], v10 offset:6144
    s_waitcnt lgkmcnt(8)
    v_mfma_f32_32x32x16_bf16 v[48:63], v[176:179], v[80:83], v[48:63]
    ds_read_b128 v[100:103], v11 offset:6144
    s_waitcnt lgkmcnt(8)
    v_mfma_f32_32x32x16_bf16 v[64:79], v[176:179], v[84:87], v[64:79]
    s_waitcnt lgkmcnt(4)
    v_max3_u32 v16, v16, v17, v18
    s_waitcnt lgkmcnt(3)
    v_max_u32 v16, v16, v19
    v_cmp_eq_u32 vcc, -1, v16
    s_nop 1
    s_or_b64 vcc, vcc, s[80:81]
    s_cbranch_scc1 Lool_142
Lret_143:
    ds_read_b128 v[80:83], v10 offset:7168
    v_mfma_f32_32x32x16_bf16 v[48:63], v[180:183], v[88:91], v[48:63]
    buffer_load_dwordx4 v[252:255], v1, s[16:19], s79 offen offset:3072 sc1
    s_barrier
    ds_read_b128 v[84:87], v11 offset:7168
    s_waitcnt lgkmcnt(4)
    v_mfma_f32_32x32x16_bf16 v[64:79], v[180:183], v[92:95], v[64:79]
    s_bfe_u32 s5, s85, 0x20006
    s_lshl_b32 s5, s5, 13
    s_add_u32 s33, s30, s5
    s_add_u32 s32, s33, 65536
    s_add_u32 m0, s84, 32768
    s_nop 0
    buffer_load_dwordx4 v1, s[16:19], s33 offen offset:0 sc1 lds
    v_bfe_u32 v4, v0, 4, 1
    v_lshlrev_b32 v4, 13, v4
    v_and_b32 v5, 15, v0
    v_lshl_add_u32 v4, v5, 6, v4
    v_lshrrev_b32 v5, 5, v0
    v_lshl_add_u32 v4, v5, 3, v4
    s_add_u32 s5, s77, 106496
    v_add_u32 v4, s5, v4
    ds_read_b64 v[104:105], v4 offset:0
    ds_read_b64 v[106:107], v4 offset:16
    ds_read_b64 v[108:109], v4 offset:32
    ds_read_b64 v[110:111], v4 offset:48
    ds_read_b128 v[88:91], v2 offset:0
    s_waitcnt lgkmcnt(8)
    v_mfma_f32_32x32x16_bf16 v[48:63], v[184:187], v[96:99], v[48:63]
    s_add_u32 m0, s84, 32768
    s_nop 0
    buffer_load_dwordx4 v1, s[16:19], s33 offen offset:1024 sc1 lds
    ds_read_b128 v[92:95], v3 offset:0
    s_waitcnt lgkmcnt(8)
    v_mfma_f32_32x32x16_bf16 v[64:79], v[184:187], v[100:103], v[64:79]
    s_add_u32 m0, s84, 40960
    s_nop 0
    buffer_load_dwordx4 v1, s[16:19], s32 offen offset:0 sc1 lds
    ds_read_b128 v[96:99], v2 offset:1024
    s_waitcnt lgkmcnt(8)
    v_mfma_f32_32x32x16_bf16 v[48:63], v[188:191], v[80:83], v[48:63]
    s_add_u32 m0, s84, 40960
    s_nop 0
    buffer_load_dwordx4 v1, s[16:19], s32 offen offset:1024 sc1 lds
    ds_read_b128 v[100:103], v3 offset:1024
    s_waitcnt lgkmcnt(8)
    v_mfma_f32_32x32x16_bf16 v[64:79], v[188:191], v[84:87], v[64:79]
    ds_read_b128 v[80:83], v2 offset:2048
    s_waitcnt lgkmcnt(4)
    v_mfma_f32_32x32x16_bf16 v[48:63], v[192:195], v[88:91], v[48:63]
    v_cmp_ne_u32 vcc, s25, v31
    s_nop 1
    s_cmp_lg_u64 vcc, 0
    s_cbranch_scc1 Lool_149
Lret_150:
    v_sub_f32 v31, 1.0, v30
    v_cvt_pk_bf16_f32 v31, v31, v31
    v_and_b32 v31, 0xffff0000, v31
    ds_read_b128 v[84:87], v3 offset:2048
    s_waitcnt lgkmcnt(4)
    v_mfma_f32_32x32x16_bf16 v[64:79], v[192:195], v[92:95], v[64:79]
    v_lshlrev_b32 v32, 16, v104
    v_and_b32 v33, 0xffff0000, v104
    v_mul_f32 v32, v32, v31
    v_mul_f32 v33, v33, v31
    v_lshlrev_b32 v34, 16, v105
    v_and_b32 v35, 0xffff0000, v105
    v_mul_f32 v34, v34, v31
    v_mul_f32 v35, v35, v31
    ds_read_b128 v[88:91], v2 offset:3072
    s_waitcnt lgkmcnt(4)
    v_mfma_f32_32x32x16_bf16 v[48:63], v[196:199], v[96:99], v[48:63]
    v_lshlrev_b32 v36, 16, v106
    v_and_b32 v37, 0xffff0000, v106
    v_mul_f32 v36, v36, v31
    v_mul_f32 v37, v37, v31
    v_lshlrev_b32 v38, 16, v107
    v_and_b32 v39, 0xffff0000, v107
    v_mul_f32 v38, v38, v31
    v_mul_f32 v39, v39, v31
    ds_read_b128 v[92:95], v3 offset:3072
    s_waitcnt lgkmcnt(4)
    v_mfma_f32_32x32x16_bf16 v[64:79], v[196:199], v[100:103], v[64:79]
    v_lshlrev_b32 v40, 16, v108
    v_and_b32 v41, 0xffff0000, v108
    v_mul_f32 v40, v40, v31
    v_mul_f32 v41, v41, v31
    v_lshlrev_b32 v42, 16, v109
    v_and_b32 v43, 0xffff0000, v109
    v_mul_f32 v42, v42, v31
    v_mul_f32 v43, v43, v31
    ds_read_b128 v[96:99], v2 offset:4096
    s_waitcnt lgkmcnt(4)
    v_mfma_f32_32x32x16_bf16 v[48:63], v[200:203], v[80:83], v[48:63]
    v_lshlrev_b32 v44, 16, v110
    v_and_b32 v45, 0xffff0000, v110
    v_mul_f32 v44, v44, v31
    v_mul_f32 v45, v45, v31
    v_lshlrev_b32 v46, 16, v111
    v_and_b32 v47, 0xffff0000, v111
    v_mul_f32 v46, v46, v31
    v_mul_f32 v47, v47, v31
    ds_read_b128 v[100:103], v3 offset:4096
    s_waitcnt lgkmcnt(4)
    v_mfma_f32_32x32x16_bf16 v[64:79], v[200:203], v[84:87], v[64:79]
    s_lshl_b32 s6, s28, 1
    s_lshr_b32 s7, s22, 2
    s_add_u32 s6, s6, s7
    s_lshr_b32 s7, s26, 5
    s_cmp_eq_u32 s6, s7
    s_cbranch_scc1 Lool_153
Lret_154:
    ds_read_b128 v[80:83], v2 offset:5120
    s_waitcnt lgkmcnt(4)
    v_mfma_f32_32x32x16_bf16 v[48:63], v[204:207], v[88:91], v[48:63]
    s_waitcnt vmcnt(0)
    ds_read_b32 v16, v12 offset:32768
    ds_read_b32 v17, v12 offset:33792
    ds_read_b32 v18, v12 offset:40960
    ds_read_b32 v19, v12 offset:41984
    ds_read_b128 v[84:87], v3 offset:5120
    s_waitcnt lgkmcnt(8)
    v_mfma_f32_32x32x16_bf16 v[64:79], v[204:207], v[92:95], v[64:79]
    ds_read_b128 v[88:91], v2 offset:6144
    s_waitcnt lgkmcnt(8)
    v_mfma_f32_32x32x16_bf16 v[48:63], v[208:211], v[96:99], v[48:63]
    ds_read_b128 v[92:95], v3 offset:6144
    s_waitcnt lgkmcnt(8)
    v_mfma_f32_32x32x16_bf16 v[64:79], v[208:211], v[100:103], v[64:79]
    s_waitcnt lgkmcnt(4)
    v_max3_u32 v16, v16, v17, v18
    s_waitcnt lgkmcnt(3)
    v_max_u32 v16, v16, v19
    v_cmp_eq_u32 vcc, -1, v16
    s_nop 1
    s_or_b64 vcc, vcc, s[80:81]
    s_cbranch_scc1 Lool_155
Lret_156:
    ds_read_b128 v[96:99], v2 offset:7168
    v_mfma_f32_32x32x16_bf16 v[48:63], v[212:215], v[80:83], v[48:63]
    s_barrier
    ds_read_b128 v[100:103], v3 offset:7168
    s_waitcnt lgkmcnt(4)
    v_mfma_f32_32x32x16_bf16 v[64:79], v[212:215], v[84:87], v[64:79]
    ds_read_b128 v[80:83], v2 offset:32768
    s_waitcnt lgkmcnt(4)
    v_mfma_f32_32x32x16_bf16 v[48:63], v[216:219], v[88:91], v[48:63]
    ds_read_b128 v[84:87], v2 offset:33792
    s_waitcnt lgkmcnt(4)
    v_mfma_f32_32x32x16_bf16 v[64:79], v[216:219], v[92:95], v[64:79]
    ds_read_b128 v[88:91], v2 offset:34816
    s_waitcnt lgkmcnt(4)
    v_mfma_f32_32x32x16_bf16 v[48:63], v[220:223], v[96:99], v[48:63]
    ds_read_b128 v[92:95], v2 offset:35840
    s_waitcnt lgkmcnt(4)
    v_mfma_f32_32x32x16_bf16 v[64:79], v[220:223], v[100:103], v[64:79]
    ds_read_b128 v[96:99], v2 offset:36864
    s_waitcnt lgkmcnt(4)
    v_mfma_f32_32x32x16_bf16 v[48:63], v[224:227], v[80:83], v[48:63]
    ds_read_b128 v[100:103], v2 offset:37888
    s_waitcnt lgkmcnt(4)
    v_mfma_f32_32x32x16_bf16 v[48:63], v[228:231], v[84:87], v[48:63]
    ds_read_b128 v[80:83], v2 offset:38912
    s_waitcnt lgkmcnt(4)
    v_mfma_f32_32x32x16_bf16 v[48:63], v[232:235], v[88:91], v[48:63]
    ds_read_b128 v[84:87], v2 offset:39936
    s_waitcnt lgkmcnt(4)
    v_mfma_f32_32x32x16_bf16 v[48:63], v[236:239], v[92:95], v[48:63]
    s_add_u32 s6, s35, 98304
    v_add_u32 v4, s6, v1
    s_xor_b32 s7, s6, 16384
    v_add_u32 v5, s7, v1
    v_lshrrev_b32 v8, 5, v0
    v_lshl_add_u32 v8, v8, 3, v28
    ds_read_b128 v[88:91], v3 offset:32768
    s_waitcnt lgkmcnt(4)
    v_mfma_f32_32x32x16_bf16 v[48:63], v[240:243], v[96:99], v[48:63]
    ds_read_b128 v[92:95], v3 offset:33792
    s_waitcnt lgkmcnt(4)
    v_mfma_f32_32x32x16_bf16 v[48:63], v[244:247], v[100:103], v[48:63]
    ds_read_b128 v[96:99], v3 offset:34816
    s_waitcnt lgkmcnt(4)
    v_mfma_f32_32x32x16_bf16 v[48:63], v[248:251], v[80:83], v[48:63]
    ds_read_b128 v[100:103], v3 offset:35840
    s_waitcnt lgkmcnt(4)
    v_mfma_f32_32x32x16_bf16 v[48:63], v[252:255], v[84:87], v[48:63]
    ds_read_b128 v[80:83], v3 offset:36864
    s_waitcnt lgkmcnt(4)
    v_mfma_f32_32x32x16_bf16 v[64:79], v[224:227], v[88:91], v[64:79]
    ds_read_b128 v[84:87], v3 offset:37888
    s_waitcnt lgkmcnt(4)
    v_mfma_f32_32x32x16_bf16 v[64:79], v[228:231], v[92:95], v[64:79]
    ds_read_b128 v[88:91], v3 offset:38912
    s_waitcnt lgkmcnt(4)
    v_mfma_f32_32x32x16_bf16 v[64:79], v[232:235], v[96:99], v[64:79]
    ds_read_b128 v[92:95], v3 offset:39936
    s_waitcnt lgkmcnt(4)
    v_mfma_f32_32x32x16_bf16 v[64:79], v[236:239], v[100:103], v[64:79]
    s_waitcnt lgkmcnt(3)
    v_mfma_f32_32x32x16_bf16 v[64:79], v[240:243], v[80:83], v[64:79]
    s_nop 6
    ds_write_b128 v4, v[48:51] offset:0
    ds_write_b128 v4, v[52:55] offset:1024
    ds_write_b128 v4, v[56:59] offset:2048
    ds_write_b128 v4, v[60:63] offset:3072
    s_waitcnt lgkmcnt(6)
    v_mfma_f32_32x32x16_bf16 v[64:79], v[244:247], v[84:87], v[64:79]
    s_waitcnt lgkmcnt(5)
    v_mfma_f32_32x32x16_bf16 v[64:79], v[248:251], v[88:91], v[64:79]
    s_waitcnt lgkmcnt(4)
    v_mfma_f32_32x32x16_bf16 v[64:79], v[252:255], v[92:95], v[64:79]
    s_waitcnt lgkmcnt(0)
    s_barrier
    ds_read_b128 v[128:131], v5 offset:0
    ds_read_b128 v[132:135], v5 offset:1024
    ds_read_b128 v[136:139], v5 offset:2048
    ds_read_b128 v[140:143], v5 offset:3072
    s_nop 5
    v_fmac_f32 v32, v64, v30
    v_fmac_f32 v33, v65, v30
    v_fmac_f32 v34, v66, v30
    v_fmac_f32 v35, v67, v30
    v_fmac_f32 v36, v68, v30
    v_fmac_f32 v37, v69, v30
    v_fmac_f32 v38, v70, v30
    v_fmac_f32 v39, v71, v30
    v_fmac_f32 v40, v72, v30
    v_fmac_f32 v41, v73, v30
    v_fmac_f32 v42, v74, v30
    v_fmac_f32 v43, v75, v30
    v_fmac_f32 v44, v76, v30
    v_fmac_f32 v45, v77, v30
    v_fmac_f32 v46, v78, v30
    v_fmac_f32 v47, v79, v30
    s_waitcnt lgkmcnt(3)
    v_fmac_f32 v32, v128, v30
    v_fmac_f32 v33, v129, v30
    v_cvt_pk_bf16_f32 v80, v32, v33
    v_fmac_f32 v34, v130, v30
    v_fmac_f32 v35, v131, v30
    v_cvt_pk_bf16_f32 v81, v34, v35
    s_waitcnt lgkmcnt(2)
    v_fmac_f32 v36, v132, v30
    v_fmac_f32 v37, v133, v30
    v_cvt_pk_bf16_f32 v82, v36, v37
    v_fmac_f32 v38, v134, v30
    v_fmac_f32 v39, v135, v30
    v_cvt_pk_bf16_f32 v83, v38, v39
    s_nop 1
    v_permlane32_swap_b32 v80, v82
    v_permlane32_swap_b32 v81, v83
    buffer_store_dwordx4 v[80:83], v8, s[40:43], 0 offen offset:0
    s_waitcnt lgkmcnt(1)
    v_fmac_f32 v40, v136, v30
    v_fmac_f32 v41, v137, v30
    v_cvt_pk_bf16_f32 v84, v40, v41
    v_fmac_f32 v42, v138, v30
    v_fmac_f32 v43, v139, v30
    v_cvt_pk_bf16_f32 v85, v42, v43
    s_waitcnt lgkmcnt(0)
    v_fmac_f32 v44, v140, v30
    v_fmac_f32 v45, v141, v30
    v_cvt_pk_bf16_f32 v86, v44, v45
    v_fmac_f32 v46, v142, v30
    v_fmac_f32 v47, v143, v30
    v_cvt_pk_bf16_f32 v87, v46, v47
    s_nop 1
    v_permlane32_swap_b32 v84, v86
    v_permlane32_swap_b32 v85, v87
    buffer_store_dwordx4 v[84:87], v8, s[40:43], 0 offen offset:32
L_exit:
    s_endpgm
Lool_17:
    v_cvt_pk_bf16_f32 v48, v136, v137
    v_cvt_pk_bf16_f32 v49, v138, v139
    v_cvt_pk_bf16_f32 v50, v160, v161
    v_cvt_pk_bf16_f32 v51, v162, v163
    v_cvt_pk_bf16_f32 v52, v140, v141
    v_cvt_pk_bf16_f32 v53, v142, v143
    v_cvt_pk_bf16_f32 v54, v164, v165
    v_cvt_pk_bf16_f32 v55, v166, v167
    v_permlane16_swap_b32 v48, v50
    v_permlane16_swap_b32 v49, v51
    buffer_store_dwordx4 v[48:51], v38, s[16:19], s6 offen offset:0 sc1
    v_cvt_pk_bf16_f32 v56, v144, v145
    v_cvt_pk_bf16_f32 v57, v146, v147
    v_cvt_pk_bf16_f32 v58, v148, v149
    v_cvt_pk_bf16_f32 v59, v150, v151
    v_permlane16_swap_b32 v52, v54
    v_permlane16_swap_b32 v53, v55
    buffer_store_dwordx4 v[52:55], v38, s[16:19], s6 offen offset:1024 sc1
    v_cvt_pk_bf16_f32 v60, v168, v169
    v_cvt_pk_bf16_f32 v61, v170, v171
    v_cvt_pk_bf16_f32 v62, v172, v173
    v_cvt_pk_bf16_f32 v63, v174, v175
    v_permlane16_swap_b32 v56, v58
    v_permlane16_swap_b32 v57, v59
    buffer_store_dwordx4 v[56:59], v1, s[16:19], s6 offen offset:2048 sc1
    v_cvt_pk_bf16_f32 v64, v184, v185
    v_cvt_pk_bf16_f32 v65, v186, v187
    v_cvt_pk_bf16_f32 v66, v208, v209
    v_cvt_pk_bf16_f32 v67, v210, v211
    v_permlane16_swap_b32 v60, v62
    v_permlane16_swap_b32 v61, v63
    buffer_store_dwordx4 v[60:63], v1, s[16:19], s6 offen offset:3072 sc1
    v_cvt_pk_bf16_f32 v68, v188, v189
    v_cvt_pk_bf16_f32 v69, v190, v191
    v_cvt_pk_bf16_f32 v70, v212, v213
    v_cvt_pk_bf16_f32 v71, v214, v215
    v_permlane16_swap_b32 v64, v66
    v_permlane16_swap_b32 v65, v67
    buffer_store_dwordx4 v[64:67], v38, s[16:19], s7 offen offset:0 sc1
    v_cvt_pk_bf16_f32 v72, v192, v193
    v_cvt_pk_bf16_f32 v73, v194, v195
    v_cvt_pk_bf16_f32 v74, v196, v197
    v_cvt_pk_bf16_f32 v75, v198, v199
    v_permlane16_swap_b32 v68, v70
    v_permlane16_swap_b32 v69, v71
    buffer_store_dwordx4 v[68:71], v38, s[16:19], s7 offen offset:1024 sc1
    v_cvt_pk_bf16_f32 v76, v216, v217
    v_cvt_pk_bf16_f32 v77, v218, v219
    v_cvt_pk_bf16_f32 v78, v220, v221
    v_cvt_pk_bf16_f32 v79, v222, v223
    v_permlane16_swap_b32 v72, v74
    v_permlane16_swap_b32 v73, v75
    buffer_store_dwordx4 v[72:75], v1, s[16:19], s7 offen offset:2048 sc1
    s_nop 1
    v_permlane16_swap_b32 v76, v78
    v_permlane16_swap_b32 v77, v79
    buffer_store_dwordx4 v[76:79], v1, s[16:19], s7 offen offset:3072 sc1
    s_branch L_kvj
    s_branch Lret_18
Lool_19:
    buffer_store_dword v5, v4, s[16:19], s5 offen sc1
    s_branch L_flj
    s_branch Lret_20
Lool_21:
    s_cmp_eq_u32 s76, 1
    s_cbranch_scc1 Lkvc2_25
    s_waitcnt vmcnt(0)
    v_cmp_ne_u32 vcc, s25, v30
    s_nop 1
    s_cmp_eq_u64 vcc, 0
    s_cbranch_scc1 Lkvok_24
    buffer_load_dword v30, v31, s[16:19], s83 offen sc1
    s_branch Lkvno_23
Lkvok_24:
    s_mov_b32 s76, 1
    s_add_u32 s32, s21, 1
    s_and_b32 s32, s32, 15
    s_lshl_b32 s32, s32, 15
    s_add_u32 s32, s32, s34
    s_add_u32 m0, s35, 131072
    s_nop 0
    buffer_load_dwordx4 v2, s[16:19], s32 offen offset:0 sc1 lds
    buffer_load_dwordx4 v2, s[16:19], s32 offen offset:1024 sc1 lds
    buffer_load_dwordx4 v2, s[16:19], s32 offen offset:2048 sc1 lds
    buffer_load_dwordx4 v2, s[16:19], s32 offen offset:3072 sc1 lds
    s_branch Lkvno_23
Lkvc2_25:
    s_mov_b32 s76, 2
    s_add_u32 s32, s21, 2
    s_and_b32 s32, s32, 15
    s_lshl_b32 s32, s32, 15
    s_add_u32 s32, s32, s34
    s_add_u32 m0, s35, 0
    s_nop 0
    buffer_load_dwordx4 v2, s[16:19], s32 offen offset:0 sc1 lds
    buffer_load_dwordx4 v2, s[16:19], s32 offen offset:1024 sc1 lds
    buffer_load_dwordx4 v2, s[16:19], s32 offen offset:2048 sc1 lds
    buffer_load_dwordx4 v2, s[16:19], s32 offen offset:3072 sc1 lds
Lkvno_23:
    s_branch Lret_22
Lool_26:
    s_cmp_eq_u32 s76, 1
    s_cbranch_scc1 Lkvc2_30
    s_waitcnt vmcnt(0)
    v_cmp_ne_u32 vcc, s25, v30
    s_nop 1
    s_cmp_eq_u64 vcc, 0
    s_cbranch_scc1 Lkvok_29
    buffer_load_dword v30, v31, s[16:19], s83 offen sc1
    s_branch Lkvno_28
Lkvok_29:
    s_mov_b32 s76, 1
    s_add_u32 s32, s21, 1
    s_and_b32 s32, s32, 15
    s_lshl_b32 s32, s32, 15
    s_add_u32 s32, s32, s34
    s_add_u32 m0, s35, 131072
    s_nop 0
    buffer_load_dwordx4 v2, s[16:19], s32 offen offset:0 sc1 lds
    buffer_load_dwordx4 v2, s[16:19], s32 offen offset:1024 sc1 lds
    buffer_load_dwordx4 v2, s[16:19], s32 offen offset:2048 sc1 lds
    buffer_load_dwordx4 v2, s[16:19], s32 offen offset:3072 sc1 lds
    s_branch Lkvno_28
Lkvc2_30:
    s_mov_b32 s76, 2
    s_add_u32 s32, s21, 2
    s_and_b32 s32, s32, 15
    s_lshl_b32 s32, s32, 15
    s_add_u32 s32, s32, s34
    s_add_u32 m0, s35, 0
    s_nop 0
    buffer_load_dwordx4 v2, s[16:19], s32 offen offset:0 sc1 lds
    buffer_load_dwordx4 v2, s[16:19], s32 offen offset:1024 sc1 lds
    buffer_load_dwordx4 v2, s[16:19], s32 offen offset:2048 sc1 lds
    buffer_load_dwordx4 v2, s[16:19], s32 offen offset:3072 sc1 lds
Lkvno_28:
    s_branch Lret_27
Lool_31:
    s_cmp_eq_u32 s76, 1
    s_cbranch_scc1 Lkvc2_35
    s_waitcnt vmcnt(0)
    v_cmp_ne_u32 vcc, s25, v30
    s_nop 1
    s_cmp_eq_u64 vcc, 0
    s_cbranch_scc1 Lkvok_34
    buffer_load_dword v30, v31, s[16:19], s83 offen sc1
    s_branch Lkvno_33
Lkvok_34:
    s_mov_b32 s76, 1
    s_add_u32 s32, s21, 1
    s_and_b32 s32, s32, 15
    s_lshl_b32 s32, s32, 15
    s_add_u32 s32, s32, s34
    s_add_u32 m0, s35, 131072
    s_nop 0
    buffer_load_dwordx4 v2, s[16:19], s32 offen offset:0 sc1 lds
    buffer_load_dwordx4 v2, s[16:19], s32 offen offset:1024 sc1 lds
    buffer_load_dwordx4 v2, s[16:19], s32 offen offset:2048 sc1 lds
    buffer_load_dwordx4 v2, s[16:19], s32 offen offset:3072 sc1 lds
    s_branch Lkvno_33
Lkvc2_35:
    s_mov_b32 s76, 2
    s_add_u32 s32, s21, 2
    s_and_b32 s32, s32, 15
    s_lshl_b32 s32, s32, 15
    s_add_u32 s32, s32, s34
    s_add_u32 m0, s35, 0
    s_nop 0
    buffer_load_dwordx4 v2, s[16:19], s32 offen offset:0 sc1 lds
    buffer_load_dwordx4 v2, s[16:19], s32 offen offset:1024 sc1 lds
    buffer_load_dwordx4 v2, s[16:19], s32 offen offset:2048 sc1 lds
    buffer_load_dwordx4 v2, s[16:19], s32 offen offset:3072 sc1 lds
Lkvno_33:
    s_branch Lret_32
Lool_36:
    s_cmp_eq_u32 s76, 1
    s_cbranch_scc1 Lkvc2_40
    s_waitcnt vmcnt(0)
    v_cmp_ne_u32 vcc, s25, v30
    s_nop 1
    s_cmp_eq_u64 vcc, 0
    s_cbranch_scc1 Lkvok_39
    s_mov_b32 s7, 262144
Lspin_41:
    buffer_load_dword v30, v31, s[16:19], s83 offen sc1
    s_waitcnt vmcnt(0)
    v_cmp_ne_u32 vcc, s25, v30
    s_nop 1
    s_cmp_eq_u64 vcc, 0
    s_cbranch_scc1 Lspun_42
    s_sleep 1
    s_sub_u32 s7, s7, 1
    s_cmp_lg_u32 s7, 0
    s_cbranch_scc1 Lspin_41
Lspun_42:
Lkvok_39:
    s_mov_b32 s76, 1
    s_add_u32 s32, s21, 1
    s_and_b32 s32, s32, 15
    s_lshl_b32 s32, s32, 15
    s_add_u32 s32, s32, s34
    s_add_u32 m0, s35, 131072
    s_nop 0
    buffer_load_dwordx4 v2, s[16:19], s32 offen offset:0 sc1 lds
    buffer_load_dwordx4 v2, s[16:19], s32 offen offset:1024 sc1 lds
    buffer_load_dwordx4 v2, s[16:19], s32 offen offset:2048 sc1 lds
    buffer_load_dwordx4 v2, s[16:19], s32 offen offset:3072 sc1 lds
Lkvc2_40:
    s_mov_b32 s76, 2
    s_add_u32 s32, s21, 2
    s_and_b32 s32, s32, 15
    s_lshl_b32 s32, s32, 15
    s_add_u32 s32, s32, s34
    s_add_u32 m0, s35, 0
    s_nop 0
    buffer_load_dwordx4 v2, s[16:19], s32 offen offset:0 sc1 lds
    buffer_load_dwordx4 v2, s[16:19], s32 offen offset:1024 sc1 lds
    buffer_load_dwordx4 v2, s[16:19], s32 offen offset:2048 sc1 lds
    buffer_load_dwordx4 v2, s[16:19], s32 offen offset:3072 sc1 lds
Lkvno_38:
    s_branch Lret_37
Lool_43:
    s_mov_b32 s97, 0x1001000
    buffer_load_dwordx4 v[208:211], v1, s[16:19], s97 offen offset:0 sc1
    buffer_load_dwordx4 v[212:215], v1, s[16:19], s97 offen offset:1024 sc1
    s_branch Lret_44
Lool_45:
    s_mov_b32 s6, 262144
Lcw_47:
    ds_read_b32 v125, v26
    s_waitcnt lgkmcnt(0)
    v_readfirstlane_b32 s5, v125
    s_nop 3
    s_cmp_ge_u32 s5, 8
    s_cbranch_scc1 Lcwd_48
    s_sub_u32 s6, s6, 1
    s_cmp_lg_u32 s6, 0
    s_cbranch_scc1 Lcw_47
Lcwd_48:
    s_branch Lret_46
Lool_49:
    s_waitcnt vmcnt(4)
    v_min_u32 v216, v209, v211
    v_max_u32 v217, v209, v211
    v_min3_u32 v216, v216, v213, v215
    v_max3_u32 v217, v217, v213, v215
    v_cmp_ne_u32 vcc, s25, v216
    v_cmp_ne_u32 s[98:99], s25, v217
    s_nop 1
    s_or_b64 vcc, vcc, s[98:99]
    s_cmp_eq_u64 vcc, 0
    s_cbranch_scc1 Lswok_51
    s_mov_b32 s7, 262144
Lspin_52:
    buffer_load_dwordx4 v[208:211], v1, s[16:19], s97 offen offset:0 sc1
    buffer_load_dwordx4 v[212:215], v1, s[16:19], s97 offen offset:1024 sc1
    s_waitcnt vmcnt(0)
    v_min_u32 v216, v209, v211
    v_max_u32 v217, v209, v211
    v_min3_u32 v216, v216, v213, v215
    v_max3_u32 v217, v217, v213, v215
    v_cmp_ne_u32 vcc, s25, v216
    v_cmp_ne_u32 s[98:99], s25, v217
    s_nop 1
    s_or_b64 vcc, vcc, s[98:99]
    s_cmp_eq_u64 vcc, 0
    s_cbranch_scc1 Lspun_53
    s_sleep 4
    s_sub_u32 s7, s7, 1
    s_cmp_lg_u32 s7, 0
    s_cbranch_scc1 Lspin_52
Lspun_53:
Lswok_51:
    v_max_u32 v216, v208, v210
    v_max3_u32 v216, v216, v212, v214
    s_nop 1
    v_max_u32_dpp v216, v216, v216 row_shr:1 bound_ctrl:0
    s_nop 1
    v_max_u32_dpp v216, v216, v216 row_shr:2 bound_ctrl:0
    s_nop 1
    v_max_u32_dpp v216, v216, v216 row_shr:4 bound_ctrl:0
    s_nop 1
    v_max_u32_dpp v216, v216, v216 row_shr:8 bound_ctrl:0
    s_nop 1
    v_max_u32_dpp v216, v216, v216 row_bcast:15 row_mask:0xa
    s_nop 1
    v_max_u32_dpp v216, v216, v216 row_bcast:31 row_mask:0xc
    v_mov_b32 v217, s25
    s_mov_b32 s5, 0x800
    s_mov_b32 s6, 0x1000000
    v_mov_b32 v4, 0
    v_mov_b32 v5, s5
    s_mov_b32 exec_lo, 0
    s_mov_b32 exec_hi, 0x80000000
    buffer_store_dwordx2 v[216:217], v5, s[16:19], s6 offen sc1
    buffer_store_dword v217, v4, s[16:19], s6 offen sc1
    s_mov_b64 exec, -1
    s_branch Lret_50
Lool_54:
    s_mov_b32 s6, 262144
Lcw_56:
    ds_read_b32 v125, v26
    s_waitcnt lgkmcnt(0)
    v_readfirstlane_b32 s5, v125
    s_nop 3
    s_cmp_ge_u32 s5, 16
    s_cbranch_scc1 Lcwd_57
    s_sub_u32 s6, s6, 1
    s_cmp_lg_u32 s6, 0
    s_cbranch_scc1 Lcw_56
Lcwd_57:
    s_branch Lret_55
Lool_58:
    s_mov_b32 s6, 262144
Lcw_60:
    ds_read_b32 v125, v26
    s_waitcnt lgkmcnt(0)
    v_readfirstlane_b32 s5, v125
    s_nop 3
    s_cmp_ge_u32 s5, 24
    s_cbranch_scc1 Lcwd_61
    s_sub_u32 s6, s6, 1
    s_cmp_lg_u32 s6, 0
    s_cbranch_scc1 Lcw_60
Lcwd_61:
    s_branch Lret_59
Lool_62:
    v_mov_b32 v4, 0
    s_mov_b32 s7, 262144
Lspin_64:
    buffer_load_dwordx2 v[30:31], v4, s[16:19], s83 offen sc1
    s_waitcnt vmcnt(0)
    v_cmp_ne_u32 vcc, s25, v31
    s_nop 1
    s_cmp_eq_u64 vcc, 0
    s_cbranch_scc1 Lspun_65
    s_sleep 16
    s_sub_u32 s7, s7, 1
    s_cmp_lg_u32 s7, 0
    s_cbranch_scc1 Lspin_64
Lspun_65:
    v_readfirstlane_b32 s27, v30
    s_nop 3
    s_branch Lret_63
Lool_66:
    s_mov_b32 s6, 262144
Lcw_68:
    ds_read_b32 v125, v26
    s_waitcnt lgkmcnt(0)
    v_readfirstlane_b32 s5, v125
    s_nop 3
    s_cmp_ge_u32 s5, 32
    s_cbranch_scc1 Lcwd_69
    s_sub_u32 s6, s6, 1
    s_cmp_lg_u32 s6, 0
    s_cbranch_scc1 Lcw_68
Lcwd_69:
    s_branch Lret_67
Lool_70:
    s_mov_b32 s6, 262144
Lcw_72:
    ds_read_b32 v125, v26
    s_waitcnt lgkmcnt(0)
    v_readfirstlane_b32 s5, v125
    s_nop 3
    s_cmp_ge_u32 s5, 40
    s_cbranch_scc1 Lcwd_73
    s_sub_u32 s6, s6, 1
    s_cmp_lg_u32 s6, 0
    s_cbranch_scc1 Lcw_72
Lcwd_73:
    s_branch Lret_71
Lool_74:
    s_mov_b32 s6, 262144
Lcw_76:
    ds_read_b32 v125, v26
    s_waitcnt lgkmcnt(0)
    v_readfirstlane_b32 s5, v125
    s_nop 3
    s_cmp_ge_u32 s5, 48
    s_cbranch_scc1 Lcwd_77
    s_sub_u32 s6, s6, 1
    s_cmp_lg_u32 s6, 0
    s_cbranch_scc1 Lcw_76
Lcwd_77:
    s_branch Lret_75
Lool_78:
    s_mov_b32 s6, 262144
Lcw_80:
    ds_read_b32 v125, v26
    s_waitcnt lgkmcnt(0)
    v_readfirstlane_b32 s5, v125
    s_nop 3
    s_cmp_ge_u32 s5, 56
    s_cbranch_scc1 Lcwd_81
    s_sub_u32 s6, s6, 1
    s_cmp_lg_u32 s6, 0
    s_cbranch_scc1 Lcw_80
Lcwd_81:
    s_branch Lret_79
Lool_82:
    s_mov_b32 s7, 262144
Lspin_84:
    buffer_load_dword v30, v31, s[16:19], s83 offen sc1
    s_waitcnt vmcnt(0)
    v_cmp_ne_u32 vcc, s25, v30
    s_nop 1
    s_cmp_eq_u64 vcc, 0
    s_cbranch_scc1 Lspun_85
    s_sleep 32
    s_sub_u32 s7, s7, 1
    s_cmp_lg_u32 s7, 0
    s_cbranch_scc1 Lspin_84
Lspun_85:
    s_branch Lret_83
Lool_86:
    s_mov_b32 s6, 262144
Lcw_88:
    ds_read_b32 v125, v26
    s_waitcnt lgkmcnt(0)
    v_readfirstlane_b32 s5, v125
    s_nop 3
    s_cmp_ge_u32 s5, 64
    s_cbranch_scc1 Lcwd_89
    s_sub_u32 s6, s6, 1
    s_cmp_lg_u32 s6, 0
    s_cbranch_scc1 Lcw_88
Lcwd_89:
    s_branch Lret_87
Lool_90:
    s_mov_b32 s6, 262144
Lcw_92:
    ds_read_b32 v125, v26
    s_waitcnt lgkmcnt(0)
    v_readfirstlane_b32 s5, v125
    s_nop 3
    s_cmp_ge_u32 s5, 72
    s_cbranch_scc1 Lcwd_93
    s_sub_u32 s6, s6, 1
    s_cmp_lg_u32 s6, 0
    s_cbranch_scc1 Lcw_92
Lcwd_93:
    s_branch Lret_91
Lool_94:
    s_mov_b32 s6, 262144
Lcw_96:
    ds_read_b32 v125, v26
    s_waitcnt lgkmcnt(0)
    v_readfirstlane_b32 s5, v125
    s_nop 3
    s_cmp_ge_u32 s5, 80
    s_cbranch_scc1 Lcwd_97
    s_sub_u32 s6, s6, 1
    s_cmp_lg_u32 s6, 0
    s_cbranch_scc1 Lcw_96
Lcwd_97:
    s_branch Lret_95
Lool_98:
    s_mov_b32 s6, 262144
Lcw_100:
    ds_read_b32 v125, v26
    s_waitcnt lgkmcnt(0)
    v_readfirstlane_b32 s5, v125
    s_nop 3
    s_cmp_ge_u32 s5, 88
    s_cbranch_scc1 Lcwd_101
    s_sub_u32 s6, s6, 1
    s_cmp_lg_u32 s6, 0
    s_cbranch_scc1 Lcw_100
Lcwd_101:
    s_branch Lret_99
Lool_102:
    v_subrev_u32 v30, 98816, v121
    v_lshlrev_b32 v30, 2, v30
    v_add_u32 v30, 106496, v30
    ds_read_b64 v[224:225], v30 offset:0
    ds_read_b64 v[226:227], v30 offset:1024
    ds_read_b64 v[228:229], v30 offset:2048
    ds_read_b64 v[230:231], v30 offset:3072
    ds_read_b64 v[232:233], v30 offset:4096
    ds_read_b64 v[234:235], v30 offset:5120
    ds_read_b64 v[236:237], v30 offset:6144
    ds_read_b64 v[238:239], v30 offset:7168
    s_waitcnt lgkmcnt(0)
    ds_read_b64 v[240:241], v30 offset:8192
    ds_read_b64 v[242:243], v30 offset:9216
    ds_read_b64 v[244:245], v30 offset:10240
    ds_read_b64 v[246:247], v30 offset:11264
    ds_read_b64 v[248:249], v30 offset:12288
    ds_read_b64 v[250:251], v30 offset:13312
    ds_read_b64 v[252:253], v30 offset:14336
    ds_read_b64 v[254:255], v30 offset:15360
    s_waitcnt lgkmcnt(0)
    v_min_u32 v30, v225, v227
    v_max_u32 v31, v225, v227
    v_min3_u32 v30, v30, v229, v231
    v_max3_u32 v31, v31, v229, v231
    v_min3_u32 v30, v30, v233, v235
    v_max3_u32 v31, v31, v233, v235
    v_min3_u32 v30, v30, v237, v239
    v_max3_u32 v31, v31, v237, v239
    v_min3_u32 v30, v30, v241, v243
    v_max3_u32 v31, v31, v241, v243
    v_min3_u32 v30, v30, v245, v247
    v_max3_u32 v31, v31, v245, v247
    v_min3_u32 v30, v30, v249, v251
    v_max3_u32 v31, v31, v249, v251
    v_min3_u32 v30, v30, v253, v255
    v_max3_u32 v31, v31, v253, v255
    v_cmp_ne_u32 vcc, s25, v30
    v_cmp_ne_u32 s[98:99], s25, v31
    s_nop 1
    s_or_b64 vcc, vcc, s[98:99]
    s_cmp_eq_u64 vcc, 0
    s_cbranch_scc1 Lhok_104
    s_mov_b32 s7, 262144
Lspin_105:
    s_mov_b32 s5, 0x1010000
    buffer_load_dwordx2 v[224:225], v122, s[16:19], s5 offen sc1
    s_add_u32 s5, s5, 28672
    buffer_load_dwordx2 v[226:227], v122, s[16:19], s5 offen sc1
    s_add_u32 s5, s5, 28672
    buffer_load_dwordx2 v[228:229], v122, s[16:19], s5 offen sc1
    s_add_u32 s5, s5, 28672
    buffer_load_dwordx2 v[230:231], v122, s[16:19], s5 offen sc1
    s_add_u32 s5, s5, 28672
    buffer_load_dwordx2 v[232:233], v122, s[16:19], s5 offen sc1
    s_add_u32 s5, s5, 28672
    buffer_load_dwordx2 v[234:235], v122, s[16:19], s5 offen sc1
    s_add_u32 s5, s5, 28672
    buffer_load_dwordx2 v[236:237], v122, s[16:19], s5 offen sc1
    s_add_u32 s5, s5, 28672
    buffer_load_dwordx2 v[238:239], v122, s[16:19], s5 offen sc1
    s_add_u32 s5, s5, 28672
    buffer_load_dwordx2 v[240:241], v122, s[16:19], s5 offen sc1
    s_add_u32 s5, s5, 28672
    buffer_load_dwordx2 v[242:243], v122, s[16:19], s5 offen sc1
    s_add_u32 s5, s5, 28672
    buffer_load_dwordx2 v[244:245], v122, s[16:19], s5 offen sc1
    s_add_u32 s5, s5, 28672
    buffer_load_dwordx2 v[246:247], v122, s[16:19], s5 offen sc1
    s_add_u32 s5, s5, 28672
    buffer_load_dwordx2 v[248:249], v122, s[16:19], s5 offen sc1
    s_add_u32 s5, s5, 28672
    buffer_load_dwordx2 v[250:251], v122, s[16:19], s5 offen sc1
    s_add_u32 s5, s5, 28672
    buffer_load_dwordx2 v[252:253], v122, s[16:19], s5 offen sc1
    s_add_u32 s5, s5, 28672
    buffer_load_dwordx2 v[254:255], v122, s[16:19], s5 offen sc1
    s_waitcnt vmcnt(0)
    v_min_u32 v30, v225, v227
    v_max_u32 v31, v225, v227
    v_min3_u32 v30, v30, v229, v231
    v_max3_u32 v31, v31, v229, v231
    v_min3_u32 v30, v30, v233, v235
    v_max3_u32 v31, v31, v233, v235
    v_min3_u32 v30, v30, v237, v239
    v_max3_u32 v31, v31, v237, v239
    v_min3_u32 v30, v30, v241, v243
    v_max3_u32 v31, v31, v241, v243
    v_min3_u32 v30, v30, v245, v247
    v_max3_u32 v31, v31, v245, v247
    v_min3_u32 v30, v30, v249, v251
    v_max3_u32 v31, v31, v249, v251
    v_min3_u32 v30, v30, v253, v255
    v_max3_u32 v31, v31, v253, v255
    v_cmp_ne_u32 vcc, s25, v30
    v_cmp_ne_u32 s[98:99], s25, v31
    s_nop 1
    s_or_b64 vcc, vcc, s[98:99]
    s_cmp_eq_u64 vcc, 0
    s_cbranch_scc1 Lspun_106
    s_sleep 12
    s_sub_u32 s7, s7, 1
    s_cmp_lg_u32 s7, 0
    s_cbranch_scc1 Lspin_105
Lspun_106:
Lhok_104:
    v_add_f32 v224, v224, v226
    v_add_f32 v240, v240, v242
    v_add_f32 v224, v224, v228
    v_add_f32 v240, v240, v244
    v_add_f32 v224, v224, v230
    v_add_f32 v240, v240, v246
    v_add_f32 v224, v224, v232
    v_add_f32 v240, v240, v248
    v_add_f32 v224, v224, v234
    v_add_f32 v240, v240, v250
    v_add_f32 v224, v224, v236
    v_add_f32 v240, v240, v252
    v_add_f32 v224, v224, v238
    v_add_f32 v240, v240, v254
    v_cvt_pk_bf16_f32 v224, v224, v224
    v_and_b32 v224, 0xffff0000, v224
    v_cvt_pk_bf16_f32 v240, v240, v240
    v_and_b32 v240, 0xffff0000, v240
    v_mov_b32 v225, v224
    v_mul_f32 v225, 0xbfb8aa3b, v225
    v_exp_f32 v225, v225
    s_nop 0
    v_add_f32 v225, 1.0, v225
    v_rcp_f32 v225, v225
    s_nop 0
    v_mul_f32 v224, v224, v225
    v_cvt_pk_bf16_f32 v224, v224, v224
    v_and_b32 v224, 0xffff0000, v224
    v_mul_f32 v224, v224, v240
    v_cvt_pk_bf16_f32 v224, v224, v224
    ds_write_b16 v121, v224
    s_waitcnt lgkmcnt(0)
    s_branch Lret_103
Lool_107:
    s_mov_b32 s6, 262144
Lcw_109:
    ds_read_b32 v125, v26
    s_waitcnt lgkmcnt(0)
    v_readfirstlane_b32 s5, v125
    s_nop 3
    s_cmp_ge_u32 s5, 96
    s_cbranch_scc1 Lcwd_110
    s_sub_u32 s6, s6, 1
    s_cmp_lg_u32 s6, 0
    s_cbranch_scc1 Lcw_109
Lcwd_110:
    s_branch Lret_108
Lool_111:
    s_mov_b32 s6, 262144
Lcw_113:
    ds_read_b32 v125, v26
    s_waitcnt lgkmcnt(0)
    v_readfirstlane_b32 s5, v125
    s_nop 3
    s_cmp_ge_u32 s5, 104
    s_cbranch_scc1 Lcwd_114
    s_sub_u32 s6, s6, 1
    s_cmp_lg_u32 s6, 0
    s_cbranch_scc1 Lcw_113
Lcwd_114:
    s_branch Lret_112
Lool_115:
    s_mov_b32 s6, 262144
Lcw_117:
    ds_read_b32 v125, v26
    s_waitcnt lgkmcnt(0)
    v_readfirstlane_b32 s5, v125
    s_nop 3
    s_cmp_ge_u32 s5, 112
    s_cbranch_scc1 Lcwd_118
    s_sub_u32 s6, s6, 1
    s_cmp_lg_u32 s6, 0
    s_cbranch_scc1 Lcw_117
Lcwd_118:
    s_branch Lret_116
Lool_119:
    s_lshl_b32 s6, s24, 14
    s_add_u32 s32, s34, s6
    v_lshrrev_b32 v4, 2, v0
    v_lshrrev_b32 v5, 4, v0
    v_xor_b32 v4, v4, v5
    v_and_b32 v4, 1, v4
    v_cmp_eq_u32 vcc, 0, v4
    v_mov_b32 v5, 0x3f803f80
    s_nop 0
    v_cndmask_b32 v16, 0, v5, vcc
    v_mov_b32 v17, v16
    v_mov_b32 v18, v16
    v_mov_b32 v19, v16
    v_mov_b32 v4, 0xff800000
    s_mov_b32 s96, 0
L_fb1:
    s_lshr_b32 s97, s96, 2
    s_lshl_b32 s97, s97, 15
    s_and_b32 s98, s96, 3
    s_lshl_b32 s98, s98, 12
    s_add_u32 s97, s97, s98
    s_add_u32 s97, s97, s32
    buffer_load_dwordx4 v[104:107], v1, s[16:19], s97 offen sc1
    buffer_load_dwordx4 v[108:111], v1, s[16:19], s97 offen offset:1024 sc1
    s_waitcnt vmcnt(0)
    v_mfma_f32_32x32x16_bf16 v[48:63], v[104:107], v[8:11], 0
    v_mfma_f32_32x32x16_bf16 v[48:63], v[108:111], v[12:15], v[48:63]
    s_nop 15
    v_max3_f32 v5, v48, v49, v50
    v_max3_f32 v5, v5, v51, v52
    v_max3_f32 v5, v5, v53, v54
    v_max3_f32 v5, v5, v55, v56
    v_max3_f32 v5, v5, v57, v58
    v_max3_f32 v5, v5, v59, v60
    v_max3_f32 v5, v5, v61, v62
    v_max_f32 v5, v5, v63
    v_max_f32 v4, v4, v5
    s_add_u32 s96, s96, 1
    s_cmp_lt_u32 s96, 64
    s_cbranch_scc1 L_fb1
    v_mov_b32 v5, v4
    s_nop 1
    v_permlane32_swap_b32 v4, v5
    v_max_f32 v4, v4, v5
    v_sub_f32 v32, 0, v4
    v_mov_b32 v80, 0
    v_sub_f32 v33, 0, v4
    v_mov_b32 v81, 0
    v_sub_f32 v34, 0, v4
    v_mov_b32 v82, 0
    v_sub_f32 v35, 0, v4
    v_mov_b32 v83, 0
    v_sub_f32 v36, 0, v4
    v_mov_b32 v84, 0
    v_sub_f32 v37, 0, v4
    v_mov_b32 v85, 0
    v_sub_f32 v38, 0, v4
    v_mov_b32 v86, 0
    v_sub_f32 v39, 0, v4
    v_mov_b32 v87, 0
    v_sub_f32 v40, 0, v4
    v_mov_b32 v88, 0
    v_sub_f32 v41, 0, v4
    v_mov_b32 v89, 0
    v_sub_f32 v42, 0, v4
    v_mov_b32 v90, 0
    v_sub_f32 v43, 0, v4
    v_mov_b32 v91, 0
    v_sub_f32 v44, 0, v4
    v_mov_b32 v92, 0
    v_sub_f32 v45, 0, v4
    v_mov_b32 v93, 0
    v_sub_f32 v46, 0, v4
    v_mov_b32 v94, 0
    v_sub_f32 v47, 0, v4
    v_mov_b32 v95, 0
    v_mov_b32 v20, 0
    v_mov_b32 v21, 0
    v_mov_b32 v22, 0
    v_mov_b32 v23, 0
    s_mov_b32 s96, 0
L_fb2:
    s_lshr_b32 s97, s96, 2
    s_lshl_b32 s97, s97, 15
    s_and_b32 s98, s96, 3
    s_lshl_b32 s98, s98, 12
    s_add_u32 s97, s97, s98
    s_add_u32 s97, s97, s32
    buffer_load_dwordx4 v[104:107], v1, s[16:19], s97 offen sc1
    buffer_load_dwordx4 v[108:111], v1, s[16:19], s97 offen offset:1024 sc1
    buffer_load_dwordx4 v[112:115], v1, s[16:19], s97 offen offset:2048 sc1
    buffer_load_dwordx4 v[116:119], v1, s[16:19], s97 offen offset:3072 sc1
    s_waitcnt vmcnt(0)
    v_mfma_f32_32x32x16_bf16 v[48:63], v[104:107], v[8:11], v[32:47]
    v_mfma_f32_32x32x16_bf16 v[48:63], v[108:111], v[12:15], v[48:63]
    s_nop 15
    v_exp_f32 v48, v48
    v_exp_f32 v49, v49
    v_exp_f32 v50, v50
    v_exp_f32 v51, v51
    v_exp_f32 v52, v52
    v_exp_f32 v53, v53
    v_exp_f32 v54, v54
    v_exp_f32 v55, v55
    v_exp_f32 v56, v56
    v_exp_f32 v57, v57
    v_exp_f32 v58, v58
    v_exp_f32 v59, v59
    v_exp_f32 v60, v60
    v_exp_f32 v61, v61
    v_exp_f32 v62, v62
    v_exp_f32 v63, v63
    s_nop 0
    v_cvt_pk_bf16_f32 v96, v48, v49
    v_cvt_pk_bf16_f32 v97, v50, v51
    v_cvt_pk_bf16_f32 v98, v52, v53
    v_cvt_pk_bf16_f32 v99, v54, v55
    v_cvt_pk_bf16_f32 v100, v56, v57
    v_cvt_pk_bf16_f32 v101, v58, v59
    v_cvt_pk_bf16_f32 v102, v60, v61
    v_cvt_pk_bf16_f32 v103, v62, v63
    s_nop 1
    v_mfma_f32_32x32x16_bf16 v[80:95], v[112:115], v[96:99], v[80:95]
    v_mfma_f32_32x32x16_bf16 v[80:95], v[116:119], v[100:103], v[80:95]
    v_mfma_f32_16x16x32_bf16 v[20:23], v[16:19], v[96:99], v[20:23]
    v_mfma_f32_16x16x32_bf16 v[20:23], v[16:19], v[100:103], v[20:23]
    s_add_u32 s96, s96, 1
    s_cmp_lt_u32 s96, 64
    s_cbranch_scc1 L_fb2
    s_nop 15
    s_branch Lret_120
Lool_121:
    v_and_b32 v8, 15, v0
    v_lshrrev_b32 v9, 4, v0
    v_lshlrev_b32 v9, 13, v9
    v_lshl_add_u32 v9, v8, 4, v9
    s_lshr_b32 s6, s22, 2
    s_lshl_b32 s6, s6, 18
    s_lshl_b32 s5, s29, 10
    s_add_u32 s6, s6, s5
    s_and_b32 s5, s22, 3
    s_lshl_b32 s5, s5, 8
    s_add_u32 s6, s6, s5
    s_add_u32 s6, s6, 0x1090000
    buffer_load_dwordx4 v[80:83], v9, s[16:19], s6 offen sc1
    s_add_u32 s6, s6, 32768
    buffer_load_dwordx4 v[84:87], v9, s[16:19], s6 offen sc1
    s_add_u32 s6, s6, 32768
    buffer_load_dwordx4 v[88:91], v9, s[16:19], s6 offen sc1
    s_add_u32 s6, s6, 32768
    buffer_load_dwordx4 v[92:95], v9, s[16:19], s6 offen sc1
    s_add_u32 s6, s6, 32768
    buffer_load_dwordx4 v[96:99], v9, s[16:19], s6 offen sc1
    s_add_u32 s6, s6, 32768
    buffer_load_dwordx4 v[100:103], v9, s[16:19], s6 offen sc1
    s_add_u32 s6, s6, 32768
    buffer_load_dwordx4 v[104:107], v9, s[16:19], s6 offen sc1
    s_add_u32 s6, s6, 32768
    buffer_load_dwordx4 v[108:111], v9, s[16:19], s6 offen sc1
    s_and_b32 s6, s27, 0xffff0000
    s_xor_b32 s7, s6, 0xffff0000
    s_bitcmp1_b32 s27, 31
    s_xor_b32 s6, s6, 0x80000000
    s_bitcmp1_b32 s27, 31
    s_cselect_b32 s6, s6, s7
    v_mov_b32 v20, s6
    v_mul_f32 v20, 0xbfb8aa3b, v20
    v_exp_f32 v20, v20
    s_nop 0
    v_add_f32 v20, 1.0, v20
    v_rcp_f32 v20, v20
    s_nop 0
    v_cvt_pk_bf16_f32 v20, v20, v20
    v_and_b32 v20, 0xffff0000, v20
    s_waitcnt vmcnt(0)
    v_min_u32 v21, v81, v83
    v_max_u32 v22, v81, v83
    v_min3_u32 v21, v21, v85, v87
    v_max3_u32 v22, v22, v85, v87
    v_min3_u32 v21, v21, v89, v91
    v_max3_u32 v22, v22, v89, v91
    v_min3_u32 v21, v21, v93, v95
    v_max3_u32 v22, v22, v93, v95
    v_min3_u32 v21, v21, v97, v99
    v_max3_u32 v22, v22, v97, v99
    v_min3_u32 v21, v21, v101, v103
    v_max3_u32 v22, v22, v101, v103
    v_min3_u32 v21, v21, v105, v107
    v_max3_u32 v22, v22, v105, v107
    v_min3_u32 v21, v21, v109, v111
    v_max3_u32 v22, v22, v109, v111
    v_cmp_ne_u32 vcc, s25, v21
    v_cmp_ne_u32 s[98:99], s25, v22
    s_nop 1
    s_or_b64 vcc, vcc, s[98:99]
    s_cmp_eq_u64 vcc, 0
    s_cbranch_scc1 Lyok_123
    s_mov_b32 s7, 262144
Lspin_124:
    s_lshr_b32 s6, s22, 2
    s_lshl_b32 s6, s6, 18
    s_lshl_b32 s5, s29, 10
    s_add_u32 s6, s6, s5
    s_and_b32 s5, s22, 3
    s_lshl_b32 s5, s5, 8
    s_add_u32 s6, s6, s5
    s_add_u32 s6, s6, 0x1090000
    buffer_load_dwordx4 v[80:83], v9, s[16:19], s6 offen sc1
    s_add_u32 s6, s6, 32768
    buffer_load_dwordx4 v[84:87], v9, s[16:19], s6 offen sc1
    s_add_u32 s6, s6, 32768
    buffer_load_dwordx4 v[88:91], v9, s[16:19], s6 offen sc1
    s_add_u32 s6, s6, 32768
    buffer_load_dwordx4 v[92:95], v9, s[16:19], s6 offen sc1
    s_add_u32 s6, s6, 32768
    buffer_load_dwordx4 v[96:99], v9, s[16:19], s6 offen sc1
    s_add_u32 s6, s6, 32768
    buffer_load_dwordx4 v[100:103], v9, s[16:19], s6 offen sc1
    s_add_u32 s6, s6, 32768
    buffer_load_dwordx4 v[104:107], v9, s[16:19], s6 offen sc1
    s_add_u32 s6, s6, 32768
    buffer_load_dwordx4 v[108:111], v9, s[16:19], s6 offen sc1
    s_waitcnt vmcnt(0)
    v_min_u32 v21, v81, v83
    v_max_u32 v22, v81, v83
    v_min3_u32 v21, v21, v85, v87
    v_max3_u32 v22, v22, v85, v87
    v_min3_u32 v21, v21, v89, v91
    v_max3_u32 v22, v22, v89, v91
    v_min3_u32 v21, v21, v93, v95
    v_max3_u32 v22, v22, v93, v95
    v_min3_u32 v21, v21, v97, v99
    v_max3_u32 v22, v22, v97, v99
    v_min3_u32 v21, v21, v101, v103
    v_max3_u32 v22, v22, v101, v103
    v_min3_u32 v21, v21, v105, v107
    v_max3_u32 v22, v22, v105, v107
    v_min3_u32 v21, v21, v109, v111
    v_max3_u32 v22, v22, v109, v111
    v_cmp_ne_u32 vcc, s25, v21
    v_cmp_ne_u32 s[98:99], s25, v22
    s_nop 1
    s_or_b64 vcc, vcc, s[98:99]
    s_cmp_eq_u64 vcc, 0
    s_cbranch_scc1 Lspun_125
    s_sleep 6
    s_sub_u32 s7, s7, 1
    s_cmp_lg_u32 s7, 0
    s_cbranch_scc1 Lspin_124
Lspun_125:
Lyok_123:
    v_add_f32 v80, v80, v84
    v_add_f32 v82, v82, v86
    v_add_f32 v80, v80, v88
    v_add_f32 v82, v82, v90
    v_add_f32 v80, v80, v92
    v_add_f32 v82, v82, v94
    v_add_f32 v80, v80, v96
    v_add_f32 v82, v82, v98
    v_add_f32 v80, v80, v100
    v_add_f32 v82, v82, v102
    v_add_f32 v80, v80, v104
    v_add_f32 v82, v82, v106
    v_add_f32 v80, v80, v108
    v_add_f32 v82, v82, v110
    v_mov_b32 v81, v80
    v_mov_b32 v83, v82
    s_nop 1
    v_permlane16_swap_b32 v80, v81
    v_permlane16_swap_b32 v82, v83
    v_add_f32 v80, v80, v81
    v_add_f32 v82, v82, v83
    v_mov_b32 v81, v80
    v_mov_b32 v83, v82
    s_nop 1
    v_permlane32_swap_b32 v80, v81
    v_permlane32_swap_b32 v82, v83
    v_add_f32 v80, v80, v81
    v_add_f32 v82, v82, v83
    v_mov_b32 v81, v82
    s_lshl_b32 s6, s22, 7
    s_add_u32 s6, s6, 122880
    v_lshl_add_u32 v9, v8, 3, s6
    ds_write_b64 v9, v[80:81]
    s_waitcnt lgkmcnt(0)
    s_branch Lret_122
Lool_126:
    s_bfe_u32 s5, s85, 0x20000
    s_lshl_b32 s5, s5, 13
    s_add_u32 s33, s30, s5
    s_add_u32 s32, s33, 65536
    s_add_u32 m0, s84, 65536
    s_nop 0
    buffer_load_dwordx4 v1, s[16:19], s33 offen offset:0 sc1 lds
    s_add_u32 m0, s84, 65536
    s_nop 0
    buffer_load_dwordx4 v1, s[16:19], s33 offen offset:1024 sc1 lds
    s_add_u32 m0, s84, 73728
    s_nop 0
    buffer_load_dwordx4 v1, s[16:19], s32 offen offset:0 sc1 lds
    s_add_u32 m0, s84, 73728
    s_nop 0
    buffer_load_dwordx4 v1, s[16:19], s32 offen offset:1024 sc1 lds
    buffer_load_dword v15, v120, s[16:19], s31 offen sc1
    s_waitcnt vmcnt(0)
    ds_read_b32 v16, v13 offset:0
    ds_read_b32 v17, v13 offset:1024
    ds_read_b32 v18, v13 offset:8192
    ds_read_b32 v19, v13 offset:9216
    s_waitcnt lgkmcnt(0)
    v_max3_u32 v16, v16, v17, v18
    v_max_u32 v16, v16, v19
    v_cmp_eq_u32 vcc, -1, v16
    s_nop 1
    s_cmp_eq_u64 vcc, 0
    s_or_b64 vcc, vcc, s[80:81]
    s_cbranch_scc0 Lrfok_128
    s_bfe_u32 s5, s85, 0x20000
    s_lshl_b32 s88, 0x11, s5
    s_mov_b32 s7, 262144
Lspin_129:
    buffer_load_dword v15, v120, s[16:19], s31 offen sc1
    s_waitcnt vmcnt(0)
    v_cmp_ne_u32 vcc, s25, v15
    s_nop 1
    s_and_b32 s5, vcc_lo, s88
    s_cmp_eq_u32 s5, 0
    s_cbranch_scc1 Lspun_130
    s_sleep 6
    s_sub_u32 s7, s7, 1
    s_cmp_lg_u32 s7, 0
    s_cbranch_scc1 Lspin_129
Lspun_130:
    s_mov_b32 s7, 262144
Lspin_131:
    s_bfe_u32 s5, s85, 0x20000
    s_lshl_b32 s5, s5, 13
    s_add_u32 s33, s30, s5
    s_add_u32 s32, s33, 65536
    s_add_u32 m0, s84, 65536
    s_nop 0
    buffer_load_dwordx4 v1, s[16:19], s33 offen offset:0 sc1 lds
    s_add_u32 m0, s84, 65536
    s_nop 0
    buffer_load_dwordx4 v1, s[16:19], s33 offen offset:1024 sc1 lds
    s_add_u32 m0, s84, 73728
    s_nop 0
    buffer_load_dwordx4 v1, s[16:19], s32 offen offset:0 sc1 lds
    s_add_u32 m0, s84, 73728
    s_nop 0
    buffer_load_dwordx4 v1, s[16:19], s32 offen offset:1024 sc1 lds
    s_waitcnt vmcnt(0)
    ds_read_b32 v16, v13 offset:0
    ds_read_b32 v17, v13 offset:1024
    ds_read_b32 v18, v13 offset:8192
    ds_read_b32 v19, v13 offset:9216
    s_waitcnt lgkmcnt(0)
    v_max3_u32 v16, v16, v17, v18
    v_max_u32 v16, v16, v19
    v_cmp_eq_u32 vcc, -1, v16
    s_nop 1
    s_cmp_eq_u64 vcc, 0
    s_cbranch_scc1 Lspun_132
    s_sleep 2
    s_sub_u32 s7, s7, 1
    s_cmp_lg_u32 s7, 0
    s_cbranch_scc1 Lspin_131
Lspun_132:
Lrfok_128:
    s_branch Lret_127
Lool_133:
    s_bfe_u32 s5, s85, 0x20002
    s_lshl_b32 s5, s5, 13
    s_add_u32 s33, s30, s5
    s_add_u32 s32, s33, 65536
    s_add_u32 m0, s84, 131072
    s_nop 0
    buffer_load_dwordx4 v1, s[16:19], s33 offen offset:0 sc1 lds
    s_add_u32 m0, s84, 131072
    s_nop 0
    buffer_load_dwordx4 v1, s[16:19], s33 offen offset:1024 sc1 lds
    s_add_u32 m0, s84, 139264
    s_nop 0
    buffer_load_dwordx4 v1, s[16:19], s32 offen offset:0 sc1 lds
    s_add_u32 m0, s84, 139264
    s_nop 0
    buffer_load_dwordx4 v1, s[16:19], s32 offen offset:1024 sc1 lds
    buffer_load_dword v15, v120, s[16:19], s31 offen sc1
    s_waitcnt vmcnt(0)
    ds_read_b32 v16, v14 offset:0
    ds_read_b32 v17, v14 offset:1024
    ds_read_b32 v18, v14 offset:8192
    ds_read_b32 v19, v14 offset:9216
    s_waitcnt lgkmcnt(0)
    v_max3_u32 v16, v16, v17, v18
    v_max_u32 v16, v16, v19
    v_cmp_eq_u32 vcc, -1, v16
    s_nop 1
    s_cmp_eq_u64 vcc, 0
    s_or_b64 vcc, vcc, s[80:81]
    s_cbranch_scc0 Lrfok_135
    s_bfe_u32 s5, s85, 0x20002
    s_lshl_b32 s88, 0x11, s5
    s_mov_b32 s7, 262144
Lspin_136:
    buffer_load_dword v15, v120, s[16:19], s31 offen sc1
    s_waitcnt vmcnt(0)
    v_cmp_ne_u32 vcc, s25, v15
    s_nop 1
    s_and_b32 s5, vcc_lo, s88
    s_cmp_eq_u32 s5, 0
    s_cbranch_scc1 Lspun_137
    s_sleep 6
    s_sub_u32 s7, s7, 1
    s_cmp_lg_u32 s7, 0
    s_cbranch_scc1 Lspin_136
Lspun_137:
    s_mov_b32 s7, 262144
Lspin_138:
    s_bfe_u32 s5, s85, 0x20002
    s_lshl_b32 s5, s5, 13
    s_add_u32 s33, s30, s5
    s_add_u32 s32, s33, 65536
    s_add_u32 m0, s84, 131072
    s_nop 0
    buffer_load_dwordx4 v1, s[16:19], s33 offen offset:0 sc1 lds
    s_add_u32 m0, s84, 131072
    s_nop 0
    buffer_load_dwordx4 v1, s[16:19], s33 offen offset:1024 sc1 lds
    s_add_u32 m0, s84, 139264
    s_nop 0
    buffer_load_dwordx4 v1, s[16:19], s32 offen offset:0 sc1 lds
    s_add_u32 m0, s84, 139264
    s_nop 0
    buffer_load_dwordx4 v1, s[16:19], s32 offen offset:1024 sc1 lds
    s_waitcnt vmcnt(0)
    ds_read_b32 v16, v14 offset:0
    ds_read_b32 v17, v14 offset:1024
    ds_read_b32 v18, v14 offset:8192
    ds_read_b32 v19, v14 offset:9216
    s_waitcnt lgkmcnt(0)
    v_max3_u32 v16, v16, v17, v18
    v_max_u32 v16, v16, v19
    v_cmp_eq_u32 vcc, -1, v16
    s_nop 1
    s_cmp_eq_u64 vcc, 0
    s_cbranch_scc1 Lspun_139
    s_sleep 2
    s_sub_u32 s7, s7, 1
    s_cmp_lg_u32 s7, 0
    s_cbranch_scc1 Lspin_138
Lspun_139:
Lrfok_135:
    s_branch Lret_134
Lool_140:
    s_and_b32 s6, s22, 3
    s_lshl_b32 s6, s6, 7
    s_add_u32 s6, s6, 122880
    v_and_b32 v8, 31, v0
    v_lshl_add_u32 v9, v8, 2, s6
    ds_read_b32 v21, v9
    ds_read_b32 v22, v9 offset:512
    s_waitcnt lgkmcnt(0)
    v_add_f32 v21, v21, v22
    v_cvt_pk_bf16_f32 v21, v21, v21
    v_and_b32 v21, 0xffff0000, v21
    v_mul_f32 v21, v21, v20
    v_cvt_pk_bf16_f32 v21, v21, v21
    v_and_b32 v21, 0xffff0000, v21
    ds_write_b32 v9, v21 offset:1024
    s_branch Lret_141
Lool_142:
    s_bfe_u32 s5, s85, 0x20004
    s_lshl_b32 s5, s5, 13
    s_add_u32 s33, s30, s5
    s_add_u32 s32, s33, 65536
    s_add_u32 m0, s84, 0
    s_nop 0
    buffer_load_dwordx4 v1, s[16:19], s33 offen offset:0 sc1 lds
    s_add_u32 m0, s84, 0
    s_nop 0
    buffer_load_dwordx4 v1, s[16:19], s33 offen offset:1024 sc1 lds
    s_add_u32 m0, s84, 8192
    s_nop 0
    buffer_load_dwordx4 v1, s[16:19], s32 offen offset:0 sc1 lds
    s_add_u32 m0, s84, 8192
    s_nop 0
    buffer_load_dwordx4 v1, s[16:19], s32 offen offset:1024 sc1 lds
    buffer_load_dword v15, v120, s[16:19], s31 offen sc1
    s_waitcnt vmcnt(0)
    ds_read_b32 v16, v12 offset:0
    ds_read_b32 v17, v12 offset:1024
    ds_read_b32 v18, v12 offset:8192
    ds_read_b32 v19, v12 offset:9216
    s_waitcnt lgkmcnt(0)
    v_max3_u32 v16, v16, v17, v18
    v_max_u32 v16, v16, v19
    v_cmp_eq_u32 vcc, -1, v16
    s_nop 1
    s_cmp_eq_u64 vcc, 0
    s_or_b64 vcc, vcc, s[80:81]
    s_cbranch_scc0 Lrfok_144
    s_bfe_u32 s5, s85, 0x20004
    s_lshl_b32 s88, 0x11, s5
    s_mov_b32 s7, 262144
Lspin_145:
    buffer_load_dword v15, v120, s[16:19], s31 offen sc1
    s_waitcnt vmcnt(0)
    v_cmp_ne_u32 vcc, s25, v15
    s_nop 1
    s_and_b32 s5, vcc_lo, s88
    s_cmp_eq_u32 s5, 0
    s_cbranch_scc1 Lspun_146
    s_sleep 6
    s_sub_u32 s7, s7, 1
    s_cmp_lg_u32 s7, 0
    s_cbranch_scc1 Lspin_145
Lspun_146:
    s_mov_b32 s7, 262144
Lspin_147:
    s_bfe_u32 s5, s85, 0x20004
    s_lshl_b32 s5, s5, 13
    s_add_u32 s33, s30, s5
    s_add_u32 s32, s33, 65536
    s_add_u32 m0, s84, 0
    s_nop 0
    buffer_load_dwordx4 v1, s[16:19], s33 offen offset:0 sc1 lds
    s_add_u32 m0, s84, 0
    s_nop 0
    buffer_load_dwordx4 v1, s[16:19], s33 offen offset:1024 sc1 lds
    s_add_u32 m0, s84, 8192
    s_nop 0
    buffer_load_dwordx4 v1, s[16:19], s32 offen offset:0 sc1 lds
    s_add_u32 m0, s84, 8192
    s_nop 0
    buffer_load_dwordx4 v1, s[16:19], s32 offen offset:1024 sc1 lds
    s_waitcnt vmcnt(0)
    ds_read_b32 v16, v12 offset:0
    ds_read_b32 v17, v12 offset:1024
    ds_read_b32 v18, v12 offset:8192
    ds_read_b32 v19, v12 offset:9216
    s_waitcnt lgkmcnt(0)
    v_max3_u32 v16, v16, v17, v18
    v_max_u32 v16, v16, v19
    v_cmp_eq_u32 vcc, -1, v16
    s_nop 1
    s_cmp_eq_u64 vcc, 0
    s_cbranch_scc1 Lspun_148
    s_sleep 2
    s_sub_u32 s7, s7, 1
    s_cmp_lg_u32 s7, 0
    s_cbranch_scc1 Lspin_147
Lspun_148:
Lrfok_144:
    s_branch Lret_143
Lool_149:
    s_mov_b32 s5, 0x1004000
    s_mov_b32 s7, 262144
Lspin_151:
    buffer_load_dwordx2 v[30:31], v29, s[16:19], s5 offen sc1
    s_waitcnt vmcnt(0)
    v_cmp_ne_u32 vcc, s25, v31
    s_nop 1
    s_cmp_eq_u64 vcc, 0
    s_cbranch_scc1 Lspun_152
    s_sleep 2
    s_sub_u32 s7, s7, 1
    s_cmp_lg_u32 s7, 0
    s_cbranch_scc1 Lspin_151
Lspun_152:
    s_branch Lret_150
Lool_153:
    s_and_b32 s6, s22, 3
    s_lshl_b32 s6, s6, 7
    s_add_u32 s6, s6, 122880
    v_and_b32 v8, 31, v0
    v_lshrrev_b32 v9, 5, v0
    v_lshl_add_u32 v9, v9, 4, s6
    ds_read_b128 v[128:131], v9 offset:1024
    ds_read_b128 v[132:135], v9 offset:1056
    ds_read_b128 v[136:139], v9 offset:1088
    ds_read_b128 v[140:143], v9 offset:1120
    s_and_b32 s7, s26, 31
    v_cmp_eq_u32 vcc, s7, v8
    s_waitcnt lgkmcnt(0)
    s_and_saveexec_b64 s[6:7], vcc
    v_fmac_f32 v32, v31, v128
    v_fmac_f32 v33, v31, v129
    v_fmac_f32 v34, v31, v130
    v_fmac_f32 v35, v31, v131
    v_fmac_f32 v36, v31, v132
    v_fmac_f32 v37, v31, v133
    v_fmac_f32 v38, v31, v134
    v_fmac_f32 v39, v31, v135
    v_fmac_f32 v40, v31, v136
    v_fmac_f32 v41, v31, v137
    v_fmac_f32 v42, v31, v138
    v_fmac_f32 v43, v31, v139
    v_fmac_f32 v44, v31, v140
    v_fmac_f32 v45, v31, v141
    v_fmac_f32 v46, v31, v142
    v_fmac_f32 v47, v31, v143
    s_mov_b64 exec, s[6:7]
    s_branch Lret_154
Lool_155:
    s_bfe_u32 s5, s85, 0x20006
    s_lshl_b32 s5, s5, 13
    s_add_u32 s33, s30, s5
    s_add_u32 s32, s33, 65536
    s_add_u32 m0, s84, 32768
    s_nop 0
    buffer_load_dwordx4 v1, s[16:19], s33 offen offset:0 sc1 lds
    s_add_u32 m0, s84, 32768
    s_nop 0
    buffer_load_dwordx4 v1, s[16:19], s33 offen offset:1024 sc1 lds
    s_add_u32 m0, s84, 40960
    s_nop 0
    buffer_load_dwordx4 v1, s[16:19], s32 offen offset:0 sc1 lds
    s_add_u32 m0, s84, 40960
    s_nop 0
    buffer_load_dwordx4 v1, s[16:19], s32 offen offset:1024 sc1 lds
    buffer_load_dword v15, v120, s[16:19], s31 offen sc1
    s_waitcnt vmcnt(0)
    ds_read_b32 v16, v12 offset:32768
    ds_read_b32 v17, v12 offset:33792
    ds_read_b32 v18, v12 offset:40960
    ds_read_b32 v19, v12 offset:41984
    s_waitcnt lgkmcnt(0)
    v_max3_u32 v16, v16, v17, v18
    v_max_u32 v16, v16, v19
    v_cmp_eq_u32 vcc, -1, v16
    s_nop 1
    s_cmp_eq_u64 vcc, 0
    s_or_b64 vcc, vcc, s[80:81]
    s_cbranch_scc0 Lrfok_157
    s_bfe_u32 s5, s85, 0x20006
    s_lshl_b32 s88, 0x11, s5
    s_mov_b32 s7, 262144
Lspin_158:
    buffer_load_dword v15, v120, s[16:19], s31 offen sc1
    s_waitcnt vmcnt(0)
    v_cmp_ne_u32 vcc, s25, v15
    s_nop 1
    s_and_b32 s5, vcc_lo, s88
    s_cmp_eq_u32 s5, 0
    s_cbranch_scc1 Lspun_159
    s_sleep 6
    s_sub_u32 s7, s7, 1
    s_cmp_lg_u32 s7, 0
    s_cbranch_scc1 Lspin_158
Lspun_159:
    s_mov_b32 s7, 262144
Lspin_160:
    s_bfe_u32 s5, s85, 0x20006
    s_lshl_b32 s5, s5, 13
    s_add_u32 s33, s30, s5
    s_add_u32 s32, s33, 65536
    s_add_u32 m0, s84, 32768
    s_nop 0
    buffer_load_dwordx4 v1, s[16:19], s33 offen offset:0 sc1 lds
    s_add_u32 m0, s84, 32768
    s_nop 0
    buffer_load_dwordx4 v1, s[16:19], s33 offen offset:1024 sc1 lds
    s_add_u32 m0, s84, 40960
    s_nop 0
    buffer_load_dwordx4 v1, s[16:19], s32 offen offset:0 sc1 lds
    s_add_u32 m0, s84, 40960
    s_nop 0
    buffer_load_dwordx4 v1, s[16:19], s32 offen offset:1024 sc1 lds
    s_waitcnt vmcnt(0)
    ds_read_b32 v16, v12 offset:32768
    ds_read_b32 v17, v12 offset:33792
    ds_read_b32 v18, v12 offset:40960
    ds_read_b32 v19, v12 offset:41984
    s_waitcnt lgkmcnt(0)
    v_max3_u32 v16, v16, v17, v18
    v_max_u32 v16, v16, v19
    v_cmp_eq_u32 vcc, -1, v16
    s_nop 1
    s_cmp_eq_u64 vcc, 0
    s_cbranch_scc1 Lspun_161
    s_sleep 2
    s_sub_u32 s7, s7, 1
    s_cmp_lg_u32 s7, 0
    s_cbranch_scc1 Lspin_160
Lspun_161:
Lrfok_157:
    s_branch Lret_156
L_end:
    s_endpgm
.section .rodata,"a"
.p2align 6
.amdhsa_kernel gated_mix__softmax_full_mha__moe_arch_mod__prompt_kernel
  .amdhsa_next_free_vgpr 256
  .amdhsa_next_free_sgpr 102
  .amdhsa_accum_offset 256
  .amdhsa_group_segment_fixed_size 0
  .amdhsa_kernarg_size 96
  .amdhsa_user_sgpr_count 2
  .amdhsa_user_sgpr_kernarg_segment_ptr 1
  .amdhsa_system_sgpr_workgroup_id_x 1
.end_amdhsa_kernel
.text
```
